```python
import torch

def _softmax(x, axis=-1):
    return torch.softmax(x, dim=axis)
def _gelu(x):
    return torch.nn.functional.gelu(x, approximate="tanh")
def _silu(x):
    return torch.nn.functional.silu(x)
def _sigmoid(x):
    return torch.sigmoid(x)
def _layernorm(x, axis=-1, eps=1e-5):
    m = x.mean(dim=axis, keepdim=True)
    v = x.var(dim=axis, keepdim=True, unbiased=False)
    return (x - m) / torch.sqrt(v + eps)
def _scatter_add(tgt, idx, src, axis=0):
    return tgt.clone().index_add_(axis, idx, src)
def _segment_sum(src, seg, n):
    out = torch.zeros((n,) + src.shape[1:], dtype=src.dtype)
    return out.index_add_(0, seg, src)
def _pad(x, pw):
    flat = tuple(v for pair in reversed(pw) for v in pair)
    return torch.nn.functional.pad(x, flat)

kernel_name = 'standalone__gqa_block_cached__near_ridge'

def setup_inputs():

    _w = (lambda a: (lambda t: t.to(torch.bfloat16) if t.is_floating_point() else t)(torch.as_tensor(a)))
    B, Sq, D = 8, 128, 448
    Hq, Hkv, Sk, Dh = 16, 8, 1024, 256
    assert Hq % Hkv == 0, (Hq, Hkv)
    return {
        "x": _w((lambda *s: torch.randn(*s, dtype=torch.bfloat16) * 0.8)(B, Sq, D)),
        "k_cache": _w((lambda *s: torch.randn(*s, dtype=torch.bfloat16) * 0.8)(B, Hkv, Sk, Dh)),
        "v_cache": _w((lambda *s: torch.randn(*s, dtype=torch.bfloat16) * 0.05)(B, Hkv, Sk, Dh)),
        "wq": _w((lambda *s: torch.randn(*s, dtype=torch.bfloat16) * 0.8)(D, Hq * Dh) * (D ** -0.5)),
        "wo": _w((lambda *s: torch.randn(*s, dtype=torch.bfloat16) * 0.05)(Hq * Dh, D) * ((Hq * Dh) ** -0.5)),
    }

def reference(x, k_cache, v_cache, wq, wo):
    B, Sq, D = x.shape
    Hq, Dh = 16, 256
    Hkv = k_cache.shape[1]
    rep = Hq // Hkv
    q = (lambda x, *d: x.permute(*d))((x @ wq).reshape(B, Sq, Hq, Dh), 0, 2, 1, 3)
    k = (lambda x, n, axis: torch.repeat_interleave(x, n, dim=axis))(k_cache, rep, axis=1)
    v = (lambda x, n, axis: torch.repeat_interleave(x, n, dim=axis))(v_cache, rep, axis=1)
    scores = torch.einsum("bhqd,bhkd->bhqk", q, k) * (Dh ** -0.5)
    p = _softmax(scores, axis=-1)
    o = torch.einsum("bhqk,bhkd->bhqd", p, v)
    return (lambda x, *d: x.permute(*d))(o, 0, 2, 1, 3).reshape(B, Sq, Hq * Dh) @ wo
```

```asm
; @launch grid=(256,1,1) block=(512,1,1) lds=163840
.amdgcn_target "amdgcn-amd-amdhsa--gfx950"
.text
.globl standalone__gqa_block_cached__near_ridge_kernel
.p2align 8
.type standalone__gqa_block_cached__near_ridge_kernel,@function
standalone__gqa_block_cached__near_ridge_kernel:
L_start:
s_cmp_ge_u32 s2, 256
s_cbranch_scc1 L_end
s_load_dwordx16 s[4:19], s[0:1], 0
v_lshrrev_b32 v1, 6, v0
s_and_b32 s20, s2, 7
v_readfirstlane_b32 s26, v1
s_lshr_b32 s21, s2, 5
s_bfe_u32 s22, s2, 0x20003
s_lshr_b32 s28, s22, 1
s_lshl_b32 s23, s20, 1
s_add_u32 s23, s23, s28
s_and_b32 s24, s22, 1
s_lshl_b32 s25, s21, 1
s_add_u32 s25, s25, s24
s_mul_i32 s27, s25, 7
s_lshr_b32 s27, s27, 4
v_and_b32 v0, 63, v0
s_cmp_lt_u32 s26, 4
s_cbranch_scc1 L_compute
s_setprio 2
s_sub_u32 s29, s26, 4
v_lshrrev_b32 v1, 3, v0
v_and_b32 v2, 7, v0
v_lshrrev_b32 v3, 1, v1
v_xor_b32 v4, v2, v3
v_lshlrev_b32 v4, 4, v4
v_mul_u32_u24 v6, 896, v1
s_mul_i32 s55, s29, 14336
v_add3_u32 v8, v6, v4, s55
v_xor_b32 v5, 64, v4
s_add_u32 s55, s55, 6144
v_add3_u32 v9, v6, v5, s55
v_and_b32 v7, 2, v1
v_xor_b32 v7, v2, v7
v_lshlrev_b32 v7, 4, v7
s_lshl_b32 s54, s29, 7
v_lshl_add_u32 v7, v1, 13, v7
v_add_u32 v12, s54, v7
v_xor_b32 v13, 64, v12
v_add_u32 v13, 64512, v13
v_add_u32 v14, 129024, v12
v_add_u32 v15, 129024, v13
v_and_b32 v3, 6, v1
v_xor_b32 v3, v2, v3
v_lshlrev_b32 v3, 4, v3
s_lshl_b32 s52, s29, 13
s_lshl_b32 s53, s29, 11
s_mul_i32 s30, s25, 57344
s_lshl_b32 s31, s23, 9
s_lshl_b32 s62, s27, 19
s_mov_b32 s34, 57344
s_mov_b32 s35, 0x20000
s_sub_u32 s46, 3670016, s31
s_mov_b32 s47, 0x20000
s_waitcnt lgkmcnt(0)
s_add_u32 s32, s4, s30
s_addc_u32 s33, s5, 0
s_add_u32 s44, s10, s31
s_addc_u32 s45, s11, 0
s_mov_b32 m0, s53
s_lshl_b32 s61, s27, 7
buffer_load_dwordx4 v8, s[32:35], s61 offen offset:0 lds
buffer_load_dwordx4 v9, s[32:35], s61 offen offset:1024 lds
s_add_u32 m0, s52, 32768
s_mov_b32 s60, s62
s_add_u32 s62, s62, 0x80000
s_cmp_ge_u32 s62, 3670016
s_cselect_b32 s62, 0, s62
buffer_load_dwordx4 v12, s[44:47], s60 offen offset:0 lds
buffer_load_dwordx4 v13, s[44:47], s60 offen offset:1024 lds
buffer_load_dwordx4 v14, s[44:47], s60 offen offset:2048 lds
buffer_load_dwordx4 v15, s[44:47], s60 offen offset:3072 lds
s_add_u32 m0, s52, 36864
s_add_u32 s60, s60, 262144
buffer_load_dwordx4 v12, s[44:47], s60 offen offset:0 lds
buffer_load_dwordx4 v13, s[44:47], s60 offen offset:1024 lds
buffer_load_dwordx4 v14, s[44:47], s60 offen offset:2048 lds
buffer_load_dwordx4 v15, s[44:47], s60 offen offset:3072 lds
s_getpc_b64 s[64:65]
L_pc_1:
s_add_u32 s64, s64, L_start-L_pc_1
s_addc_u32 s65, s65, -1
s_lshr_b32 s66, s2, 3
s_lshl_b32 s66, s66, 2
s_add_u32 s66, s66, s29
s_lshl_b32 s66, s66, 7
s_min_u32 s66, s66, L_code_end-L_start-128
s_add_u32 s64, s64, s66
s_addc_u32 s65, s65, 0
s_load_dword s67, s[64:65], 0
s_load_dword s67, s[64:65], 64
s_cmp_eq_u32 s28, 0
s_cselect_b32 s30, 1, 6
s_add_u32 s61, s30, s27
s_cmp_ge_u32 s30, 4
s_cselect_b32 s31, 32768, 0
s_lshl_b32 s30, s30, 13
s_add_u32 s30, s30, s31
s_add_u32 m0, s30, s53
s_sub_u32 s31, s61, 7
s_cmp_ge_u32 s61, 7
s_cselect_b32 s61, s31, s61
s_lshl_b32 s61, s61, 7
buffer_load_dwordx4 v8, s[32:35], s61 offen offset:0 lds
buffer_load_dwordx4 v9, s[32:35], s61 offen offset:1024 lds
s_cmp_eq_u32 s28, 0
s_cselect_b32 s30, 2, 5
s_add_u32 s61, s30, s27
s_cmp_ge_u32 s30, 4
s_cselect_b32 s31, 32768, 0
s_lshl_b32 s30, s30, 13
s_add_u32 s30, s30, s31
s_add_u32 m0, s30, s53
s_sub_u32 s31, s61, 7
s_cmp_ge_u32 s61, 7
s_cselect_b32 s61, s31, s61
s_lshl_b32 s61, s61, 7
buffer_load_dwordx4 v8, s[32:35], s61 offen offset:0 lds
buffer_load_dwordx4 v9, s[32:35], s61 offen offset:1024 lds
s_cmp_eq_u32 s28, 0
s_cselect_b32 s30, 3, 4
s_add_u32 s61, s30, s27
s_cmp_ge_u32 s30, 4
s_cselect_b32 s31, 32768, 0
s_lshl_b32 s30, s30, 13
s_add_u32 s30, s30, s31
s_add_u32 m0, s30, s53
s_sub_u32 s31, s61, 7
s_cmp_ge_u32 s61, 7
s_cselect_b32 s61, s31, s61
s_lshl_b32 s61, s61, 7
buffer_load_dwordx4 v8, s[32:35], s61 offen offset:0 lds
buffer_load_dwordx4 v9, s[32:35], s61 offen offset:1024 lds
s_cmp_eq_u32 s28, 0
s_cselect_b32 s30, 4, 3
s_add_u32 s61, s30, s27
s_cmp_ge_u32 s30, 4
s_cselect_b32 s31, 32768, 0
s_lshl_b32 s30, s30, 13
s_add_u32 s30, s30, s31
s_add_u32 m0, s30, s53
s_sub_u32 s31, s61, 7
s_cmp_ge_u32 s61, 7
s_cselect_b32 s61, s31, s61
s_lshl_b32 s61, s61, 7
buffer_load_dwordx4 v8, s[32:35], s61 offen offset:0 lds
buffer_load_dwordx4 v9, s[32:35], s61 offen offset:1024 lds
v_lshl_add_u32 v7, v1, 9, s52
v_add_u32 v16, v7, v4
v_add_u32 v17, v7, v5
v_add_u32 v20, v7, v3
s_movk_i32 s55, 8064
s_mov_b32 s59, s55
s_mul_i32 s55, s29, 57344
v_add3_u32 v24, v6, v3, s55
v_add_u32 v25, 6144, v24
v_add_u32 v26, 12288, v24
v_add_u32 v27, 18432, v24
s_lshl_b32 s30, s21, 3
s_add_u32 s30, s30, s20
s_lshl_b32 s30, s30, 19
s_add_u32 s36, s6, s30
s_addc_u32 s37, s7, 0
s_mov_b32 s38, 0x80000
s_mov_b32 s39, 0x20000
s_add_u32 s40, s8, s30
s_addc_u32 s41, s9, 0
s_mov_b32 s42, 0x80000
s_mov_b32 s43, 0x20000
s_mul_i32 s30, s23, 229376
s_add_u32 s48, s12, s30
s_addc_u32 s49, s13, 0
s_mov_b32 s50, 229376
s_mov_b32 s51, 0x20000
s_lshl_b32 s63, s27, 7
s_lshl_b32 s68, s22, 2
s_add_u32 s68, s68, s29
s_mul_i32 s68, s68, 0
s_lshl_b32 s69, s25, 2
s_add_u32 s69, s69, s29
s_mul_i32 s69, s69, 3584
s_mov_b32 s56, 1969500448
s_cmp_eq_u32 s22, 1
s_cselect_b32 s56, 2253603344, s56
s_cmp_eq_u32 s22, 2
s_cselect_b32 s56, 1733567233, s56
s_cmp_eq_u32 s22, 3
s_cselect_b32 s56, 1984246273, s56
s_mov_b32 s57, 4260149672
s_cmp_eq_u32 s22, 1
s_cselect_b32 s57, 4275817111, s57
s_cmp_eq_u32 s22, 2
s_cselect_b32 s57, 4024216472, s57
s_cmp_eq_u32 s22, 3
s_cselect_b32 s57, 4274895497, s57
s_waitcnt vmcnt(8)
s_barrier
s_cmp_eq_u32 s28, 0
s_cselect_b32 s30, 5, 2
s_add_u32 s61, s30, s27
s_cmp_ge_u32 s30, 4
s_cselect_b32 s31, 32768, 0
s_lshl_b32 s30, s30, 13
s_add_u32 s30, s30, s31
s_add_u32 m0, s30, s53
s_sub_u32 s31, s61, 7
s_cmp_ge_u32 s61, 7
s_cselect_b32 s61, s31, s61
s_lshl_b32 s61, s61, 7
buffer_load_dwordx4 v8, s[32:35], s61 offen offset:0 lds
buffer_load_dwordx4 v9, s[32:35], s61 offen offset:1024 lds
s_cmp_eq_u32 s28, 0
s_cselect_b32 s30, 6, 1
s_add_u32 s61, s30, s27
s_cmp_ge_u32 s30, 4
s_cselect_b32 s31, 32768, 0
s_lshl_b32 s30, s30, 13
s_add_u32 s30, s30, s31
s_add_u32 m0, s30, s53
s_sub_u32 s31, s61, 7
s_cmp_ge_u32 s61, 7
s_cselect_b32 s61, s31, s61
s_lshl_b32 s61, s61, 7
buffer_load_dwordx4 v8, s[32:35], s61 offen offset:0 lds
buffer_load_dwordx4 v9, s[32:35], s61 offen offset:1024 lds
s_add_u32 m0, s52, 98304
s_mov_b32 s60, s62
s_add_u32 s62, s62, 0x80000
s_cmp_ge_u32 s62, 3670016
s_cselect_b32 s62, 0, s62
buffer_load_dwordx4 v12, s[44:47], s60 offen offset:0 lds
buffer_load_dwordx4 v13, s[44:47], s60 offen offset:1024 lds
buffer_load_dwordx4 v14, s[44:47], s60 offen offset:2048 lds
buffer_load_dwordx4 v15, s[44:47], s60 offen offset:3072 lds
s_add_u32 m0, s52, 102400
s_add_u32 s60, s60, 262144
buffer_load_dwordx4 v12, s[44:47], s60 offen offset:0 lds
buffer_load_dwordx4 v13, s[44:47], s60 offen offset:1024 lds
buffer_load_dwordx4 v14, s[44:47], s60 offen offset:2048 lds
buffer_load_dwordx4 v15, s[44:47], s60 offen offset:3072 lds
s_add_u32 m0, s52, 131072
s_mov_b32 s60, s62
s_add_u32 s62, s62, 0x80000
s_cmp_ge_u32 s62, 3670016
s_cselect_b32 s62, 0, s62
buffer_load_dwordx4 v12, s[44:47], s60 offen offset:0 lds
buffer_load_dwordx4 v13, s[44:47], s60 offen offset:1024 lds
buffer_load_dwordx4 v14, s[44:47], s60 offen offset:2048 lds
buffer_load_dwordx4 v15, s[44:47], s60 offen offset:3072 lds
s_add_u32 m0, s52, 135168
s_add_u32 s60, s60, 262144
buffer_load_dwordx4 v12, s[44:47], s60 offen offset:0 lds
buffer_load_dwordx4 v13, s[44:47], s60 offen offset:1024 lds
buffer_load_dwordx4 v14, s[44:47], s60 offen offset:2048 lds
buffer_load_dwordx4 v15, s[44:47], s60 offen offset:3072 lds
s_waitcnt vmcnt(8)
s_barrier
s_add_u32 m0, s52, 32768
s_mov_b32 s60, s62
s_add_u32 s62, s62, 0x80000
s_cmp_ge_u32 s62, 3670016
s_cselect_b32 s62, 0, s62
buffer_load_dwordx4 v12, s[44:47], s60 offen offset:0 lds
buffer_load_dwordx4 v13, s[44:47], s60 offen offset:1024 lds
buffer_load_dwordx4 v14, s[44:47], s60 offen offset:2048 lds
buffer_load_dwordx4 v15, s[44:47], s60 offen offset:3072 lds
s_add_u32 m0, s52, 36864
s_add_u32 s60, s60, 262144
buffer_load_dwordx4 v12, s[44:47], s60 offen offset:0 lds
buffer_load_dwordx4 v13, s[44:47], s60 offen offset:1024 lds
buffer_load_dwordx4 v14, s[44:47], s60 offen offset:2048 lds
buffer_load_dwordx4 v15, s[44:47], s60 offen offset:3072 lds
s_waitcnt vmcnt(8)
s_barrier
s_add_u32 m0, s52, 0
s_mov_b32 s60, s62
s_add_u32 s62, s62, 0x80000
s_cmp_ge_u32 s62, 3670016
s_cselect_b32 s62, 0, s62
buffer_load_dwordx4 v12, s[44:47], s60 offen offset:0 lds
buffer_load_dwordx4 v13, s[44:47], s60 offen offset:1024 lds
buffer_load_dwordx4 v14, s[44:47], s60 offen offset:2048 lds
buffer_load_dwordx4 v15, s[44:47], s60 offen offset:3072 lds
s_add_u32 m0, s52, 4096
s_add_u32 s60, s60, 262144
buffer_load_dwordx4 v12, s[44:47], s60 offen offset:0 lds
buffer_load_dwordx4 v13, s[44:47], s60 offen offset:1024 lds
buffer_load_dwordx4 v14, s[44:47], s60 offen offset:2048 lds
buffer_load_dwordx4 v15, s[44:47], s60 offen offset:3072 lds
s_waitcnt vmcnt(8)
s_barrier
s_getpc_b64 s[64:65]
L_pc_2:
s_add_u32 s64, s64, L_att-L_pc_2
s_addc_u32 s65, s65, 0
s_lshr_b32 s66, s2, 3
s_lshl_b32 s66, s66, 2
s_add_u32 s66, s66, s29
s_lshl_b32 s66, s66, 7
s_min_u32 s66, s66, L_code_end-L_att-128
s_add_u32 s64, s64, s66
s_addc_u32 s65, s65, 0
s_load_dword s67, s[64:65], 0
s_load_dword s67, s[64:65], 64
s_add_u32 m0, s52, 65536
s_mov_b32 s60, s62
s_add_u32 s62, s62, 0x80000
s_cmp_ge_u32 s62, 3670016
s_cselect_b32 s62, 0, s62
buffer_load_dwordx4 v12, s[44:47], s60 offen offset:0 lds
buffer_load_dwordx4 v13, s[44:47], s60 offen offset:1024 lds
buffer_load_dwordx4 v14, s[44:47], s60 offen offset:2048 lds
buffer_load_dwordx4 v15, s[44:47], s60 offen offset:3072 lds
s_add_u32 m0, s52, 69632
s_add_u32 s60, s60, 262144
buffer_load_dwordx4 v12, s[44:47], s60 offen offset:0 lds
buffer_load_dwordx4 v13, s[44:47], s60 offen offset:1024 lds
buffer_load_dwordx4 v14, s[44:47], s60 offen offset:2048 lds
buffer_load_dwordx4 v15, s[44:47], s60 offen offset:3072 lds
s_waitcnt vmcnt(8)
s_barrier
s_add_u32 m0, s52, 98304
s_mov_b32 s60, s62
s_add_u32 s62, s62, 0x80000
s_cmp_ge_u32 s62, 3670016
s_cselect_b32 s62, 0, s62
buffer_load_dwordx4 v12, s[44:47], s60 offen offset:0 lds
buffer_load_dwordx4 v13, s[44:47], s60 offen offset:1024 lds
buffer_load_dwordx4 v14, s[44:47], s60 offen offset:2048 lds
buffer_load_dwordx4 v15, s[44:47], s60 offen offset:3072 lds
s_add_u32 m0, s52, 102400
s_add_u32 s60, s60, 262144
buffer_load_dwordx4 v12, s[44:47], s60 offen offset:0 lds
buffer_load_dwordx4 v13, s[44:47], s60 offen offset:1024 lds
buffer_load_dwordx4 v14, s[44:47], s60 offen offset:2048 lds
buffer_load_dwordx4 v15, s[44:47], s60 offen offset:3072 lds
s_waitcnt vmcnt(8)
s_barrier
s_add_u32 m0, s53, 131072
s_bfe_u32 s60, s56, 262144
s_lshl_b32 s60, s60, 15
buffer_load_dwordx4 v16, s[36:39], s60 offen offset:0 lds
s_add_u32 m0, m0, s59
s_nop 0
buffer_load_dwordx4 v16, s[36:39], s60 offen offset:128 lds
s_add_u32 m0, m0, s59
s_nop 0
buffer_load_dwordx4 v16, s[36:39], s60 offen offset:256 lds
s_add_u32 m0, m0, s59
s_nop 0
buffer_load_dwordx4 v16, s[36:39], s60 offen offset:384 lds
s_add_u32 m0, s53, 132096
s_add_u32 s60, s60, 4096
buffer_load_dwordx4 v17, s[36:39], s60 offen offset:0 lds
s_add_u32 m0, m0, s59
s_nop 0
buffer_load_dwordx4 v17, s[36:39], s60 offen offset:128 lds
s_add_u32 m0, m0, s59
s_nop 0
buffer_load_dwordx4 v17, s[36:39], s60 offen offset:256 lds
s_add_u32 m0, m0, s59
s_nop 0
buffer_load_dwordx4 v17, s[36:39], s60 offen offset:384 lds
s_waitcnt vmcnt(8)
s_barrier
s_barrier
s_add_u32 m0, s53, 32768
s_bfe_u32 s60, s56, 262144
s_lshl_b32 s60, s60, 15
buffer_load_dwordx4 v20, s[40:43], s60 offen offset:0 lds
s_add_u32 m0, m0, s59
s_nop 0
buffer_load_dwordx4 v20, s[40:43], s60 offen offset:128 lds
s_add_u32 m0, m0, s59
s_nop 0
buffer_load_dwordx4 v20, s[40:43], s60 offen offset:256 lds
s_add_u32 m0, m0, s59
s_nop 0
buffer_load_dwordx4 v20, s[40:43], s60 offen offset:384 lds
s_add_u32 m0, s53, 33792
s_add_u32 s60, s60, 4096
buffer_load_dwordx4 v20, s[40:43], s60 offen offset:0 lds
s_add_u32 m0, m0, s59
s_nop 0
buffer_load_dwordx4 v20, s[40:43], s60 offen offset:128 lds
s_add_u32 m0, m0, s59
s_nop 0
buffer_load_dwordx4 v20, s[40:43], s60 offen offset:256 lds
s_add_u32 m0, m0, s59
s_nop 0
buffer_load_dwordx4 v20, s[40:43], s60 offen offset:384 lds
s_waitcnt vmcnt(8)
s_barrier
s_add_u32 m0, s53, 0
s_bfe_u32 s60, s56, 262148
s_lshl_b32 s60, s60, 15
buffer_load_dwordx4 v16, s[36:39], s60 offen offset:0 lds
s_add_u32 m0, m0, s59
s_nop 0
buffer_load_dwordx4 v16, s[36:39], s60 offen offset:128 lds
s_add_u32 m0, m0, s59
s_nop 0
buffer_load_dwordx4 v16, s[36:39], s60 offen offset:256 lds
s_add_u32 m0, m0, s59
s_nop 0
buffer_load_dwordx4 v16, s[36:39], s60 offen offset:384 lds
s_add_u32 m0, s53, 1024
s_add_u32 s60, s60, 4096
buffer_load_dwordx4 v17, s[36:39], s60 offen offset:0 lds
s_add_u32 m0, m0, s59
s_nop 0
buffer_load_dwordx4 v17, s[36:39], s60 offen offset:128 lds
s_add_u32 m0, m0, s59
s_nop 0
buffer_load_dwordx4 v17, s[36:39], s60 offen offset:256 lds
s_add_u32 m0, m0, s59
s_nop 0
buffer_load_dwordx4 v17, s[36:39], s60 offen offset:384 lds
s_add_u32 m0, s53, 98304
s_bfe_u32 s60, s56, 262148
s_lshl_b32 s60, s60, 15
buffer_load_dwordx4 v20, s[40:43], s60 offen offset:0 lds
s_add_u32 m0, m0, s59
s_nop 0
buffer_load_dwordx4 v20, s[40:43], s60 offen offset:128 lds
s_add_u32 m0, m0, s59
s_nop 0
buffer_load_dwordx4 v20, s[40:43], s60 offen offset:256 lds
s_add_u32 m0, m0, s59
s_nop 0
buffer_load_dwordx4 v20, s[40:43], s60 offen offset:384 lds
s_add_u32 m0, s53, 99328
s_add_u32 s60, s60, 4096
buffer_load_dwordx4 v20, s[40:43], s60 offen offset:0 lds
s_add_u32 m0, m0, s59
s_nop 0
buffer_load_dwordx4 v20, s[40:43], s60 offen offset:128 lds
s_add_u32 m0, m0, s59
s_nop 0
buffer_load_dwordx4 v20, s[40:43], s60 offen offset:256 lds
s_add_u32 m0, m0, s59
s_nop 0
buffer_load_dwordx4 v20, s[40:43], s60 offen offset:384 lds
s_waitcnt vmcnt(8)
s_barrier
s_add_u32 m0, s53, 65536
s_bfe_u32 s60, s56, 262152
s_lshl_b32 s60, s60, 15
buffer_load_dwordx4 v16, s[36:39], s60 offen offset:0 lds
s_add_u32 m0, m0, s59
s_nop 0
buffer_load_dwordx4 v16, s[36:39], s60 offen offset:128 lds
s_add_u32 m0, m0, s59
s_nop 0
buffer_load_dwordx4 v16, s[36:39], s60 offen offset:256 lds
s_add_u32 m0, m0, s59
s_nop 0
buffer_load_dwordx4 v16, s[36:39], s60 offen offset:384 lds
s_add_u32 m0, s53, 66560
s_add_u32 s60, s60, 4096
buffer_load_dwordx4 v17, s[36:39], s60 offen offset:0 lds
s_add_u32 m0, m0, s59
s_nop 0
buffer_load_dwordx4 v17, s[36:39], s60 offen offset:128 lds
s_add_u32 m0, m0, s59
s_nop 0
buffer_load_dwordx4 v17, s[36:39], s60 offen offset:256 lds
s_add_u32 m0, m0, s59
s_nop 0
buffer_load_dwordx4 v17, s[36:39], s60 offen offset:384 lds
s_barrier
s_add_u32 m0, s53, 131072
s_bfe_u32 s60, s56, 262152
s_lshl_b32 s60, s60, 15
buffer_load_dwordx4 v20, s[40:43], s60 offen offset:0 lds
s_add_u32 m0, m0, s59
s_nop 0
buffer_load_dwordx4 v20, s[40:43], s60 offen offset:128 lds
s_add_u32 m0, m0, s59
s_nop 0
buffer_load_dwordx4 v20, s[40:43], s60 offen offset:256 lds
s_add_u32 m0, m0, s59
s_nop 0
buffer_load_dwordx4 v20, s[40:43], s60 offen offset:384 lds
s_add_u32 m0, s53, 132096
s_add_u32 s60, s60, 4096
buffer_load_dwordx4 v20, s[40:43], s60 offen offset:0 lds
s_add_u32 m0, m0, s59
s_nop 0
buffer_load_dwordx4 v20, s[40:43], s60 offen offset:128 lds
s_add_u32 m0, m0, s59
s_nop 0
buffer_load_dwordx4 v20, s[40:43], s60 offen offset:256 lds
s_add_u32 m0, m0, s59
s_nop 0
buffer_load_dwordx4 v20, s[40:43], s60 offen offset:384 lds
s_waitcnt vmcnt(8)
s_barrier
s_add_u32 m0, s53, 0
s_bfe_u32 s60, s56, 262156
s_lshl_b32 s60, s60, 15
buffer_load_dwordx4 v16, s[36:39], s60 offen offset:0 lds
s_add_u32 m0, m0, s59
s_nop 0
buffer_load_dwordx4 v16, s[36:39], s60 offen offset:128 lds
s_add_u32 m0, m0, s59
s_nop 0
buffer_load_dwordx4 v16, s[36:39], s60 offen offset:256 lds
s_add_u32 m0, m0, s59
s_nop 0
buffer_load_dwordx4 v16, s[36:39], s60 offen offset:384 lds
s_add_u32 m0, s53, 1024
s_add_u32 s60, s60, 4096
buffer_load_dwordx4 v17, s[36:39], s60 offen offset:0 lds
s_add_u32 m0, m0, s59
s_nop 0
buffer_load_dwordx4 v17, s[36:39], s60 offen offset:128 lds
s_add_u32 m0, m0, s59
s_nop 0
buffer_load_dwordx4 v17, s[36:39], s60 offen offset:256 lds
s_add_u32 m0, m0, s59
s_nop 0
buffer_load_dwordx4 v17, s[36:39], s60 offen offset:384 lds
s_barrier
s_add_u32 m0, s53, 32768
s_bfe_u32 s60, s56, 262156
s_lshl_b32 s60, s60, 15
buffer_load_dwordx4 v20, s[40:43], s60 offen offset:0 lds
s_add_u32 m0, m0, s59
s_nop 0
buffer_load_dwordx4 v20, s[40:43], s60 offen offset:128 lds
s_add_u32 m0, m0, s59
s_nop 0
buffer_load_dwordx4 v20, s[40:43], s60 offen offset:256 lds
s_add_u32 m0, m0, s59
s_nop 0
buffer_load_dwordx4 v20, s[40:43], s60 offen offset:384 lds
s_add_u32 m0, s53, 33792
s_add_u32 s60, s60, 4096
buffer_load_dwordx4 v20, s[40:43], s60 offen offset:0 lds
s_add_u32 m0, m0, s59
s_nop 0
buffer_load_dwordx4 v20, s[40:43], s60 offen offset:128 lds
s_add_u32 m0, m0, s59
s_nop 0
buffer_load_dwordx4 v20, s[40:43], s60 offen offset:256 lds
s_add_u32 m0, m0, s59
s_nop 0
buffer_load_dwordx4 v20, s[40:43], s60 offen offset:384 lds
s_waitcnt vmcnt(8)
s_barrier
s_add_u32 m0, s53, 65536
s_bfe_u32 s60, s56, 262160
s_lshl_b32 s60, s60, 15
buffer_load_dwordx4 v16, s[36:39], s60 offen offset:0 lds
s_add_u32 m0, m0, s59
s_nop 0
buffer_load_dwordx4 v16, s[36:39], s60 offen offset:128 lds
s_add_u32 m0, m0, s59
s_nop 0
buffer_load_dwordx4 v16, s[36:39], s60 offen offset:256 lds
s_add_u32 m0, m0, s59
s_nop 0
buffer_load_dwordx4 v16, s[36:39], s60 offen offset:384 lds
s_add_u32 m0, s53, 66560
s_add_u32 s60, s60, 4096
buffer_load_dwordx4 v17, s[36:39], s60 offen offset:0 lds
s_add_u32 m0, m0, s59
s_nop 0
buffer_load_dwordx4 v17, s[36:39], s60 offen offset:128 lds
s_add_u32 m0, m0, s59
s_nop 0
buffer_load_dwordx4 v17, s[36:39], s60 offen offset:256 lds
s_add_u32 m0, m0, s59
s_nop 0
buffer_load_dwordx4 v17, s[36:39], s60 offen offset:384 lds
s_barrier
s_add_u32 m0, s53, 98304
s_bfe_u32 s60, s56, 262160
s_lshl_b32 s60, s60, 15
buffer_load_dwordx4 v20, s[40:43], s60 offen offset:0 lds
s_add_u32 m0, m0, s59
s_nop 0
buffer_load_dwordx4 v20, s[40:43], s60 offen offset:128 lds
s_add_u32 m0, m0, s59
s_nop 0
buffer_load_dwordx4 v20, s[40:43], s60 offen offset:256 lds
s_add_u32 m0, m0, s59
s_nop 0
buffer_load_dwordx4 v20, s[40:43], s60 offen offset:384 lds
s_add_u32 m0, s53, 99328
s_add_u32 s60, s60, 4096
buffer_load_dwordx4 v20, s[40:43], s60 offen offset:0 lds
s_add_u32 m0, m0, s59
s_nop 0
buffer_load_dwordx4 v20, s[40:43], s60 offen offset:128 lds
s_add_u32 m0, m0, s59
s_nop 0
buffer_load_dwordx4 v20, s[40:43], s60 offen offset:256 lds
s_add_u32 m0, m0, s59
s_nop 0
buffer_load_dwordx4 v20, s[40:43], s60 offen offset:384 lds
s_waitcnt vmcnt(8)
s_barrier
s_add_u32 m0, s53, 0
s_bfe_u32 s60, s56, 262164
s_lshl_b32 s60, s60, 15
buffer_load_dwordx4 v16, s[36:39], s60 offen offset:0 lds
s_add_u32 m0, m0, s59
s_nop 0
buffer_load_dwordx4 v16, s[36:39], s60 offen offset:128 lds
s_add_u32 m0, m0, s59
s_nop 0
buffer_load_dwordx4 v16, s[36:39], s60 offen offset:256 lds
s_add_u32 m0, m0, s59
s_nop 0
buffer_load_dwordx4 v16, s[36:39], s60 offen offset:384 lds
s_add_u32 m0, s53, 1024
s_add_u32 s60, s60, 4096
buffer_load_dwordx4 v17, s[36:39], s60 offen offset:0 lds
s_add_u32 m0, m0, s59
s_nop 0
buffer_load_dwordx4 v17, s[36:39], s60 offen offset:128 lds
s_add_u32 m0, m0, s59
s_nop 0
buffer_load_dwordx4 v17, s[36:39], s60 offen offset:256 lds
s_add_u32 m0, m0, s59
s_nop 0
buffer_load_dwordx4 v17, s[36:39], s60 offen offset:384 lds
s_barrier
s_add_u32 m0, s53, 131072
s_bfe_u32 s60, s56, 262164
s_lshl_b32 s60, s60, 15
buffer_load_dwordx4 v20, s[40:43], s60 offen offset:0 lds
s_add_u32 m0, m0, s59
s_nop 0
buffer_load_dwordx4 v20, s[40:43], s60 offen offset:128 lds
s_add_u32 m0, m0, s59
s_nop 0
buffer_load_dwordx4 v20, s[40:43], s60 offen offset:256 lds
s_add_u32 m0, m0, s59
s_nop 0
buffer_load_dwordx4 v20, s[40:43], s60 offen offset:384 lds
s_add_u32 m0, s53, 132096
s_add_u32 s60, s60, 4096
buffer_load_dwordx4 v20, s[40:43], s60 offen offset:0 lds
s_add_u32 m0, m0, s59
s_nop 0
buffer_load_dwordx4 v20, s[40:43], s60 offen offset:128 lds
s_add_u32 m0, m0, s59
s_nop 0
buffer_load_dwordx4 v20, s[40:43], s60 offen offset:256 lds
s_add_u32 m0, m0, s59
s_nop 0
buffer_load_dwordx4 v20, s[40:43], s60 offen offset:384 lds
s_waitcnt vmcnt(8)
s_barrier
s_add_u32 m0, s53, 65536
s_bfe_u32 s60, s56, 262168
s_lshl_b32 s60, s60, 15
buffer_load_dwordx4 v16, s[36:39], s60 offen offset:0 lds
s_add_u32 m0, m0, s59
s_nop 0
buffer_load_dwordx4 v16, s[36:39], s60 offen offset:128 lds
s_add_u32 m0, m0, s59
s_nop 0
buffer_load_dwordx4 v16, s[36:39], s60 offen offset:256 lds
s_add_u32 m0, m0, s59
s_nop 0
buffer_load_dwordx4 v16, s[36:39], s60 offen offset:384 lds
s_add_u32 m0, s53, 66560
s_add_u32 s60, s60, 4096
buffer_load_dwordx4 v17, s[36:39], s60 offen offset:0 lds
s_add_u32 m0, m0, s59
s_nop 0
buffer_load_dwordx4 v17, s[36:39], s60 offen offset:128 lds
s_add_u32 m0, m0, s59
s_nop 0
buffer_load_dwordx4 v17, s[36:39], s60 offen offset:256 lds
s_add_u32 m0, m0, s59
s_nop 0
buffer_load_dwordx4 v17, s[36:39], s60 offen offset:384 lds
s_barrier
s_add_u32 m0, s53, 32768
s_bfe_u32 s60, s56, 262168
s_lshl_b32 s60, s60, 15
buffer_load_dwordx4 v20, s[40:43], s60 offen offset:0 lds
s_add_u32 m0, m0, s59
s_nop 0
buffer_load_dwordx4 v20, s[40:43], s60 offen offset:128 lds
s_add_u32 m0, m0, s59
s_nop 0
buffer_load_dwordx4 v20, s[40:43], s60 offen offset:256 lds
s_add_u32 m0, m0, s59
s_nop 0
buffer_load_dwordx4 v20, s[40:43], s60 offen offset:384 lds
s_add_u32 m0, s53, 33792
s_add_u32 s60, s60, 4096
buffer_load_dwordx4 v20, s[40:43], s60 offen offset:0 lds
s_add_u32 m0, m0, s59
s_nop 0
buffer_load_dwordx4 v20, s[40:43], s60 offen offset:128 lds
s_add_u32 m0, m0, s59
s_nop 0
buffer_load_dwordx4 v20, s[40:43], s60 offen offset:256 lds
s_add_u32 m0, m0, s59
s_nop 0
buffer_load_dwordx4 v20, s[40:43], s60 offen offset:384 lds
s_waitcnt vmcnt(8)
s_barrier
s_add_u32 m0, s53, 0
s_bfe_u32 s60, s56, 262172
s_lshl_b32 s60, s60, 15
buffer_load_dwordx4 v16, s[36:39], s60 offen offset:0 lds
s_add_u32 m0, m0, s59
s_nop 0
buffer_load_dwordx4 v16, s[36:39], s60 offen offset:128 lds
s_add_u32 m0, m0, s59
s_nop 0
buffer_load_dwordx4 v16, s[36:39], s60 offen offset:256 lds
s_add_u32 m0, m0, s59
s_nop 0
buffer_load_dwordx4 v16, s[36:39], s60 offen offset:384 lds
s_add_u32 m0, s53, 1024
s_add_u32 s60, s60, 4096
buffer_load_dwordx4 v17, s[36:39], s60 offen offset:0 lds
s_add_u32 m0, m0, s59
s_nop 0
buffer_load_dwordx4 v17, s[36:39], s60 offen offset:128 lds
s_add_u32 m0, m0, s59
s_nop 0
buffer_load_dwordx4 v17, s[36:39], s60 offen offset:256 lds
s_add_u32 m0, m0, s59
s_nop 0
buffer_load_dwordx4 v17, s[36:39], s60 offen offset:384 lds
s_barrier
s_add_u32 m0, s53, 98304
s_bfe_u32 s60, s56, 262172
s_lshl_b32 s60, s60, 15
buffer_load_dwordx4 v20, s[40:43], s60 offen offset:0 lds
s_add_u32 m0, m0, s59
s_nop 0
buffer_load_dwordx4 v20, s[40:43], s60 offen offset:128 lds
s_add_u32 m0, m0, s59
s_nop 0
buffer_load_dwordx4 v20, s[40:43], s60 offen offset:256 lds
s_add_u32 m0, m0, s59
s_nop 0
buffer_load_dwordx4 v20, s[40:43], s60 offen offset:384 lds
s_add_u32 m0, s53, 99328
s_add_u32 s60, s60, 4096
buffer_load_dwordx4 v20, s[40:43], s60 offen offset:0 lds
s_add_u32 m0, m0, s59
s_nop 0
buffer_load_dwordx4 v20, s[40:43], s60 offen offset:128 lds
s_add_u32 m0, m0, s59
s_nop 0
buffer_load_dwordx4 v20, s[40:43], s60 offen offset:256 lds
s_add_u32 m0, m0, s59
s_nop 0
buffer_load_dwordx4 v20, s[40:43], s60 offen offset:384 lds
s_waitcnt vmcnt(8)
s_barrier
s_add_u32 m0, s53, 65536
s_bfe_u32 s60, s57, 262144
s_lshl_b32 s60, s60, 15
buffer_load_dwordx4 v16, s[36:39], s60 offen offset:0 lds
s_add_u32 m0, m0, s59
s_nop 0
buffer_load_dwordx4 v16, s[36:39], s60 offen offset:128 lds
s_add_u32 m0, m0, s59
s_nop 0
buffer_load_dwordx4 v16, s[36:39], s60 offen offset:256 lds
s_add_u32 m0, m0, s59
s_nop 0
buffer_load_dwordx4 v16, s[36:39], s60 offen offset:384 lds
s_add_u32 m0, s53, 66560
s_add_u32 s60, s60, 4096
buffer_load_dwordx4 v17, s[36:39], s60 offen offset:0 lds
s_add_u32 m0, m0, s59
s_nop 0
buffer_load_dwordx4 v17, s[36:39], s60 offen offset:128 lds
s_add_u32 m0, m0, s59
s_nop 0
buffer_load_dwordx4 v17, s[36:39], s60 offen offset:256 lds
s_add_u32 m0, m0, s59
s_nop 0
buffer_load_dwordx4 v17, s[36:39], s60 offen offset:384 lds
s_barrier
s_add_u32 m0, s53, 131072
s_bfe_u32 s60, s57, 262144
s_lshl_b32 s60, s60, 15
buffer_load_dwordx4 v20, s[40:43], s60 offen offset:0 lds
s_add_u32 m0, m0, s59
s_nop 0
buffer_load_dwordx4 v20, s[40:43], s60 offen offset:128 lds
s_add_u32 m0, m0, s59
s_nop 0
buffer_load_dwordx4 v20, s[40:43], s60 offen offset:256 lds
s_add_u32 m0, m0, s59
s_nop 0
buffer_load_dwordx4 v20, s[40:43], s60 offen offset:384 lds
s_add_u32 m0, s53, 132096
s_add_u32 s60, s60, 4096
buffer_load_dwordx4 v20, s[40:43], s60 offen offset:0 lds
s_add_u32 m0, m0, s59
s_nop 0
buffer_load_dwordx4 v20, s[40:43], s60 offen offset:128 lds
s_add_u32 m0, m0, s59
s_nop 0
buffer_load_dwordx4 v20, s[40:43], s60 offen offset:256 lds
s_add_u32 m0, m0, s59
s_nop 0
buffer_load_dwordx4 v20, s[40:43], s60 offen offset:384 lds
s_waitcnt vmcnt(8)
s_barrier
s_add_u32 m0, s53, 0
s_bfe_u32 s60, s57, 262148
s_lshl_b32 s60, s60, 15
buffer_load_dwordx4 v16, s[36:39], s60 offen offset:0 lds
s_add_u32 m0, m0, s59
s_nop 0
buffer_load_dwordx4 v16, s[36:39], s60 offen offset:128 lds
s_add_u32 m0, m0, s59
s_nop 0
buffer_load_dwordx4 v16, s[36:39], s60 offen offset:256 lds
s_add_u32 m0, m0, s59
s_nop 0
buffer_load_dwordx4 v16, s[36:39], s60 offen offset:384 lds
s_add_u32 m0, s53, 1024
s_add_u32 s60, s60, 4096
buffer_load_dwordx4 v17, s[36:39], s60 offen offset:0 lds
s_add_u32 m0, m0, s59
s_nop 0
buffer_load_dwordx4 v17, s[36:39], s60 offen offset:128 lds
s_add_u32 m0, m0, s59
s_nop 0
buffer_load_dwordx4 v17, s[36:39], s60 offen offset:256 lds
s_add_u32 m0, m0, s59
s_nop 0
buffer_load_dwordx4 v17, s[36:39], s60 offen offset:384 lds
s_barrier
s_add_u32 m0, s53, 32768
s_bfe_u32 s60, s57, 262148
s_lshl_b32 s60, s60, 15
buffer_load_dwordx4 v20, s[40:43], s60 offen offset:0 lds
s_add_u32 m0, m0, s59
s_nop 0
buffer_load_dwordx4 v20, s[40:43], s60 offen offset:128 lds
s_add_u32 m0, m0, s59
s_nop 0
buffer_load_dwordx4 v20, s[40:43], s60 offen offset:256 lds
s_add_u32 m0, m0, s59
s_nop 0
buffer_load_dwordx4 v20, s[40:43], s60 offen offset:384 lds
s_add_u32 m0, s53, 33792
s_add_u32 s60, s60, 4096
buffer_load_dwordx4 v20, s[40:43], s60 offen offset:0 lds
s_add_u32 m0, m0, s59
s_nop 0
buffer_load_dwordx4 v20, s[40:43], s60 offen offset:128 lds
s_add_u32 m0, m0, s59
s_nop 0
buffer_load_dwordx4 v20, s[40:43], s60 offen offset:256 lds
s_add_u32 m0, m0, s59
s_nop 0
buffer_load_dwordx4 v20, s[40:43], s60 offen offset:384 lds
s_waitcnt vmcnt(8)
s_barrier
s_add_u32 m0, s53, 65536
s_bfe_u32 s60, s57, 262152
s_lshl_b32 s60, s60, 15
buffer_load_dwordx4 v16, s[36:39], s60 offen offset:0 lds
s_add_u32 m0, m0, s59
s_nop 0
buffer_load_dwordx4 v16, s[36:39], s60 offen offset:128 lds
s_add_u32 m0, m0, s59
s_nop 0
buffer_load_dwordx4 v16, s[36:39], s60 offen offset:256 lds
s_add_u32 m0, m0, s59
s_nop 0
buffer_load_dwordx4 v16, s[36:39], s60 offen offset:384 lds
s_add_u32 m0, s53, 66560
s_add_u32 s60, s60, 4096
buffer_load_dwordx4 v17, s[36:39], s60 offen offset:0 lds
s_add_u32 m0, m0, s59
s_nop 0
buffer_load_dwordx4 v17, s[36:39], s60 offen offset:128 lds
s_add_u32 m0, m0, s59
s_nop 0
buffer_load_dwordx4 v17, s[36:39], s60 offen offset:256 lds
s_add_u32 m0, m0, s59
s_nop 0
buffer_load_dwordx4 v17, s[36:39], s60 offen offset:384 lds
s_barrier
s_add_u32 m0, s53, 98304
s_bfe_u32 s60, s57, 262152
s_lshl_b32 s60, s60, 15
buffer_load_dwordx4 v20, s[40:43], s60 offen offset:0 lds
s_add_u32 m0, m0, s59
s_nop 0
buffer_load_dwordx4 v20, s[40:43], s60 offen offset:128 lds
s_add_u32 m0, m0, s59
s_nop 0
buffer_load_dwordx4 v20, s[40:43], s60 offen offset:256 lds
s_add_u32 m0, m0, s59
s_nop 0
buffer_load_dwordx4 v20, s[40:43], s60 offen offset:384 lds
s_add_u32 m0, s53, 99328
s_add_u32 s60, s60, 4096
buffer_load_dwordx4 v20, s[40:43], s60 offen offset:0 lds
s_add_u32 m0, m0, s59
s_nop 0
buffer_load_dwordx4 v20, s[40:43], s60 offen offset:128 lds
s_add_u32 m0, m0, s59
s_nop 0
buffer_load_dwordx4 v20, s[40:43], s60 offen offset:256 lds
s_add_u32 m0, m0, s59
s_nop 0
buffer_load_dwordx4 v20, s[40:43], s60 offen offset:384 lds
s_waitcnt vmcnt(8)
s_barrier
s_add_u32 m0, s53, 0
s_bfe_u32 s60, s57, 262156
s_lshl_b32 s60, s60, 15
buffer_load_dwordx4 v16, s[36:39], s60 offen offset:0 lds
s_add_u32 m0, m0, s59
s_nop 0
buffer_load_dwordx4 v16, s[36:39], s60 offen offset:128 lds
s_add_u32 m0, m0, s59
s_nop 0
buffer_load_dwordx4 v16, s[36:39], s60 offen offset:256 lds
s_add_u32 m0, m0, s59
s_nop 0
buffer_load_dwordx4 v16, s[36:39], s60 offen offset:384 lds
s_add_u32 m0, s53, 1024
s_add_u32 s60, s60, 4096
buffer_load_dwordx4 v17, s[36:39], s60 offen offset:0 lds
s_add_u32 m0, m0, s59
s_nop 0
buffer_load_dwordx4 v17, s[36:39], s60 offen offset:128 lds
s_add_u32 m0, m0, s59
s_nop 0
buffer_load_dwordx4 v17, s[36:39], s60 offen offset:256 lds
s_add_u32 m0, m0, s59
s_nop 0
buffer_load_dwordx4 v17, s[36:39], s60 offen offset:384 lds
s_barrier
s_add_u32 m0, s53, 131072
s_bfe_u32 s60, s57, 262156
s_lshl_b32 s60, s60, 15
buffer_load_dwordx4 v20, s[40:43], s60 offen offset:0 lds
s_add_u32 m0, m0, s59
s_nop 0
buffer_load_dwordx4 v20, s[40:43], s60 offen offset:128 lds
s_add_u32 m0, m0, s59
s_nop 0
buffer_load_dwordx4 v20, s[40:43], s60 offen offset:256 lds
s_add_u32 m0, m0, s59
s_nop 0
buffer_load_dwordx4 v20, s[40:43], s60 offen offset:384 lds
s_add_u32 m0, s53, 132096
s_add_u32 s60, s60, 4096
buffer_load_dwordx4 v20, s[40:43], s60 offen offset:0 lds
s_add_u32 m0, m0, s59
s_nop 0
buffer_load_dwordx4 v20, s[40:43], s60 offen offset:128 lds
s_add_u32 m0, m0, s59
s_nop 0
buffer_load_dwordx4 v20, s[40:43], s60 offen offset:256 lds
s_add_u32 m0, m0, s59
s_nop 0
buffer_load_dwordx4 v20, s[40:43], s60 offen offset:384 lds
s_waitcnt vmcnt(8)
s_barrier
s_add_u32 m0, s53, 65536
s_bfe_u32 s60, s57, 262160
s_lshl_b32 s60, s60, 15
buffer_load_dwordx4 v16, s[36:39], s60 offen offset:0 lds
s_add_u32 m0, m0, s59
s_nop 0
buffer_load_dwordx4 v16, s[36:39], s60 offen offset:128 lds
s_add_u32 m0, m0, s59
s_nop 0
buffer_load_dwordx4 v16, s[36:39], s60 offen offset:256 lds
s_add_u32 m0, m0, s59
s_nop 0
buffer_load_dwordx4 v16, s[36:39], s60 offen offset:384 lds
s_add_u32 m0, s53, 66560
s_add_u32 s60, s60, 4096
buffer_load_dwordx4 v17, s[36:39], s60 offen offset:0 lds
s_add_u32 m0, m0, s59
s_nop 0
buffer_load_dwordx4 v17, s[36:39], s60 offen offset:128 lds
s_add_u32 m0, m0, s59
s_nop 0
buffer_load_dwordx4 v17, s[36:39], s60 offen offset:256 lds
s_add_u32 m0, m0, s59
s_nop 0
buffer_load_dwordx4 v17, s[36:39], s60 offen offset:384 lds
s_barrier
s_add_u32 m0, s53, 32768
s_bfe_u32 s60, s57, 262160
s_lshl_b32 s60, s60, 15
buffer_load_dwordx4 v20, s[40:43], s60 offen offset:0 lds
s_add_u32 m0, m0, s59
s_nop 0
buffer_load_dwordx4 v20, s[40:43], s60 offen offset:128 lds
s_add_u32 m0, m0, s59
s_nop 0
buffer_load_dwordx4 v20, s[40:43], s60 offen offset:256 lds
s_add_u32 m0, m0, s59
s_nop 0
buffer_load_dwordx4 v20, s[40:43], s60 offen offset:384 lds
s_add_u32 m0, s53, 33792
s_add_u32 s60, s60, 4096
buffer_load_dwordx4 v20, s[40:43], s60 offen offset:0 lds
s_add_u32 m0, m0, s59
s_nop 0
buffer_load_dwordx4 v20, s[40:43], s60 offen offset:128 lds
s_add_u32 m0, m0, s59
s_nop 0
buffer_load_dwordx4 v20, s[40:43], s60 offen offset:256 lds
s_add_u32 m0, m0, s59
s_nop 0
buffer_load_dwordx4 v20, s[40:43], s60 offen offset:384 lds
s_waitcnt vmcnt(8)
s_barrier
s_add_u32 m0, s53, 0
s_bfe_u32 s60, s57, 262164
s_lshl_b32 s60, s60, 15
buffer_load_dwordx4 v16, s[36:39], s60 offen offset:0 lds
s_add_u32 m0, m0, s59
s_nop 0
buffer_load_dwordx4 v16, s[36:39], s60 offen offset:128 lds
s_add_u32 m0, m0, s59
s_nop 0
buffer_load_dwordx4 v16, s[36:39], s60 offen offset:256 lds
s_add_u32 m0, m0, s59
s_nop 0
buffer_load_dwordx4 v16, s[36:39], s60 offen offset:384 lds
s_add_u32 m0, s53, 1024
s_add_u32 s60, s60, 4096
buffer_load_dwordx4 v17, s[36:39], s60 offen offset:0 lds
s_add_u32 m0, m0, s59
s_nop 0
buffer_load_dwordx4 v17, s[36:39], s60 offen offset:128 lds
s_add_u32 m0, m0, s59
s_nop 0
buffer_load_dwordx4 v17, s[36:39], s60 offen offset:256 lds
s_add_u32 m0, m0, s59
s_nop 0
buffer_load_dwordx4 v17, s[36:39], s60 offen offset:384 lds
s_barrier
s_add_u32 m0, s53, 98304
s_bfe_u32 s60, s57, 262164
s_lshl_b32 s60, s60, 15
buffer_load_dwordx4 v20, s[40:43], s60 offen offset:0 lds
s_add_u32 m0, m0, s59
s_nop 0
buffer_load_dwordx4 v20, s[40:43], s60 offen offset:128 lds
s_add_u32 m0, m0, s59
s_nop 0
buffer_load_dwordx4 v20, s[40:43], s60 offen offset:256 lds
s_add_u32 m0, m0, s59
s_nop 0
buffer_load_dwordx4 v20, s[40:43], s60 offen offset:384 lds
s_add_u32 m0, s53, 99328
s_add_u32 s60, s60, 4096
buffer_load_dwordx4 v20, s[40:43], s60 offen offset:0 lds
s_add_u32 m0, m0, s59
s_nop 0
buffer_load_dwordx4 v20, s[40:43], s60 offen offset:128 lds
s_add_u32 m0, m0, s59
s_nop 0
buffer_load_dwordx4 v20, s[40:43], s60 offen offset:256 lds
s_add_u32 m0, m0, s59
s_nop 0
buffer_load_dwordx4 v20, s[40:43], s60 offen offset:384 lds
s_waitcnt vmcnt(8)
s_barrier
s_getpc_b64 s[64:65]
L_pc_3:
s_add_u32 s64, s64, L_post-L_pc_3
s_addc_u32 s65, s65, 0
s_lshr_b32 s66, s2, 3
s_lshl_b32 s66, s66, 2
s_add_u32 s66, s66, s29
s_lshl_b32 s66, s66, 7
s_min_u32 s66, s66, L_code_end-L_post-128
s_add_u32 s64, s64, s66
s_addc_u32 s65, s65, 0
s_load_dword s67, s[64:65], 0
s_load_dword s67, s[64:65], 64
s_add_u32 m0, s53, 65536
s_bfe_u32 s60, s57, 262168
s_lshl_b32 s60, s60, 15
buffer_load_dwordx4 v16, s[36:39], s60 offen offset:0 lds
s_add_u32 m0, m0, s59
s_nop 0
buffer_load_dwordx4 v16, s[36:39], s60 offen offset:128 lds
s_add_u32 m0, m0, s59
s_nop 0
buffer_load_dwordx4 v16, s[36:39], s60 offen offset:256 lds
s_add_u32 m0, m0, s59
s_nop 0
buffer_load_dwordx4 v16, s[36:39], s60 offen offset:384 lds
s_add_u32 m0, s53, 66560
s_add_u32 s60, s60, 4096
buffer_load_dwordx4 v17, s[36:39], s60 offen offset:0 lds
s_add_u32 m0, m0, s59
s_nop 0
buffer_load_dwordx4 v17, s[36:39], s60 offen offset:128 lds
s_add_u32 m0, m0, s59
s_nop 0
buffer_load_dwordx4 v17, s[36:39], s60 offen offset:256 lds
s_add_u32 m0, m0, s59
s_nop 0
buffer_load_dwordx4 v17, s[36:39], s60 offen offset:384 lds
s_barrier
s_add_u32 m0, s53, 131072
s_bfe_u32 s60, s57, 262168
s_lshl_b32 s60, s60, 15
buffer_load_dwordx4 v20, s[40:43], s60 offen offset:0 lds
s_add_u32 m0, m0, s59
s_nop 0
buffer_load_dwordx4 v20, s[40:43], s60 offen offset:128 lds
s_add_u32 m0, m0, s59
s_nop 0
buffer_load_dwordx4 v20, s[40:43], s60 offen offset:256 lds
s_add_u32 m0, m0, s59
s_nop 0
buffer_load_dwordx4 v20, s[40:43], s60 offen offset:384 lds
s_add_u32 m0, s53, 132096
s_add_u32 s60, s60, 4096
buffer_load_dwordx4 v20, s[40:43], s60 offen offset:0 lds
s_add_u32 m0, m0, s59
s_nop 0
buffer_load_dwordx4 v20, s[40:43], s60 offen offset:128 lds
s_add_u32 m0, m0, s59
s_nop 0
buffer_load_dwordx4 v20, s[40:43], s60 offen offset:256 lds
s_add_u32 m0, m0, s59
s_nop 0
buffer_load_dwordx4 v20, s[40:43], s60 offen offset:384 lds
s_waitcnt vmcnt(8)
s_barrier
s_add_u32 m0, s53, 0
s_bfe_u32 s60, s57, 262172
s_lshl_b32 s60, s60, 15
buffer_load_dwordx4 v16, s[36:39], s60 offen offset:0 lds
s_add_u32 m0, m0, s59
s_nop 0
buffer_load_dwordx4 v16, s[36:39], s60 offen offset:128 lds
s_add_u32 m0, m0, s59
s_nop 0
buffer_load_dwordx4 v16, s[36:39], s60 offen offset:256 lds
s_add_u32 m0, m0, s59
s_nop 0
buffer_load_dwordx4 v16, s[36:39], s60 offen offset:384 lds
s_add_u32 m0, s53, 1024
s_add_u32 s60, s60, 4096
buffer_load_dwordx4 v17, s[36:39], s60 offen offset:0 lds
s_add_u32 m0, m0, s59
s_nop 0
buffer_load_dwordx4 v17, s[36:39], s60 offen offset:128 lds
s_add_u32 m0, m0, s59
s_nop 0
buffer_load_dwordx4 v17, s[36:39], s60 offen offset:256 lds
s_add_u32 m0, m0, s59
s_nop 0
buffer_load_dwordx4 v17, s[36:39], s60 offen offset:384 lds
s_barrier
s_add_u32 m0, s53, 32768
s_bfe_u32 s60, s57, 262172
s_lshl_b32 s60, s60, 15
buffer_load_dwordx4 v20, s[40:43], s60 offen offset:0 lds
s_add_u32 m0, m0, s59
s_nop 0
buffer_load_dwordx4 v20, s[40:43], s60 offen offset:128 lds
s_add_u32 m0, m0, s59
s_nop 0
buffer_load_dwordx4 v20, s[40:43], s60 offen offset:256 lds
s_add_u32 m0, m0, s59
s_nop 0
buffer_load_dwordx4 v20, s[40:43], s60 offen offset:384 lds
s_add_u32 m0, s53, 33792
s_add_u32 s60, s60, 4096
buffer_load_dwordx4 v20, s[40:43], s60 offen offset:0 lds
s_add_u32 m0, m0, s59
s_nop 0
buffer_load_dwordx4 v20, s[40:43], s60 offen offset:128 lds
s_add_u32 m0, m0, s59
s_nop 0
buffer_load_dwordx4 v20, s[40:43], s60 offen offset:256 lds
s_add_u32 m0, m0, s59
s_nop 0
buffer_load_dwordx4 v20, s[40:43], s60 offen offset:384 lds
s_waitcnt vmcnt(8)
s_barrier
s_add_u32 m0, s52, 65536
s_mov_b32 s60, s63
s_add_u32 s63, s63, 128
s_cmp_ge_u32 s63, 896
s_cselect_b32 s63, 0, s63
buffer_load_dwordx4 v24, s[48:51], s60 offen offset:0 lds
buffer_load_dwordx4 v25, s[48:51], s60 offen offset:1024 lds
buffer_load_dwordx4 v26, s[48:51], s60 offen offset:2048 lds
buffer_load_dwordx4 v27, s[48:51], s60 offen offset:3072 lds
s_add_u32 m0, s52, 69632
s_add_u32 s60, s60, 28672
buffer_load_dwordx4 v24, s[48:51], s60 offen offset:0 lds
buffer_load_dwordx4 v25, s[48:51], s60 offen offset:1024 lds
buffer_load_dwordx4 v26, s[48:51], s60 offen offset:2048 lds
buffer_load_dwordx4 v27, s[48:51], s60 offen offset:3072 lds
s_barrier
s_add_u32 m0, s52, 98304
s_mov_b32 s60, s63
s_add_u32 s63, s63, 128
s_cmp_ge_u32 s63, 896
s_cselect_b32 s63, 0, s63
buffer_load_dwordx4 v24, s[48:51], s60 offen offset:0 lds
buffer_load_dwordx4 v25, s[48:51], s60 offen offset:1024 lds
buffer_load_dwordx4 v26, s[48:51], s60 offen offset:2048 lds
buffer_load_dwordx4 v27, s[48:51], s60 offen offset:3072 lds
s_add_u32 m0, s52, 102400
s_add_u32 s60, s60, 28672
buffer_load_dwordx4 v24, s[48:51], s60 offen offset:0 lds
buffer_load_dwordx4 v25, s[48:51], s60 offen offset:1024 lds
buffer_load_dwordx4 v26, s[48:51], s60 offen offset:2048 lds
buffer_load_dwordx4 v27, s[48:51], s60 offen offset:3072 lds
s_waitcnt vmcnt(16)
s_barrier
s_barrier
s_add_u32 m0, s52, 131072
s_mov_b32 s60, s63
s_add_u32 s63, s63, 128
s_cmp_ge_u32 s63, 896
s_cselect_b32 s63, 0, s63
buffer_load_dwordx4 v24, s[48:51], s60 offen offset:0 lds
buffer_load_dwordx4 v25, s[48:51], s60 offen offset:1024 lds
buffer_load_dwordx4 v26, s[48:51], s60 offen offset:2048 lds
buffer_load_dwordx4 v27, s[48:51], s60 offen offset:3072 lds
s_barrier
s_add_u32 m0, s52, 135168
s_add_u32 s60, s60, 28672
buffer_load_dwordx4 v24, s[48:51], s60 offen offset:0 lds
buffer_load_dwordx4 v25, s[48:51], s60 offen offset:1024 lds
buffer_load_dwordx4 v26, s[48:51], s60 offen offset:2048 lds
buffer_load_dwordx4 v27, s[48:51], s60 offen offset:3072 lds
s_waitcnt vmcnt(16)
s_barrier
s_add_u32 m0, s52, 32768
s_mov_b32 s60, s63
s_add_u32 s63, s63, 128
s_cmp_ge_u32 s63, 896
s_cselect_b32 s63, 0, s63
buffer_load_dwordx4 v24, s[48:51], s60 offen offset:0 lds
buffer_load_dwordx4 v25, s[48:51], s60 offen offset:1024 lds
buffer_load_dwordx4 v26, s[48:51], s60 offen offset:2048 lds
buffer_load_dwordx4 v27, s[48:51], s60 offen offset:3072 lds
s_add_u32 m0, s52, 36864
s_add_u32 s60, s60, 28672
buffer_load_dwordx4 v24, s[48:51], s60 offen offset:0 lds
buffer_load_dwordx4 v25, s[48:51], s60 offen offset:1024 lds
buffer_load_dwordx4 v26, s[48:51], s60 offen offset:2048 lds
buffer_load_dwordx4 v27, s[48:51], s60 offen offset:3072 lds
s_waitcnt vmcnt(16)
s_barrier
s_add_u32 m0, s52, 0
s_mov_b32 s60, s63
s_add_u32 s63, s63, 128
s_cmp_ge_u32 s63, 896
s_cselect_b32 s63, 0, s63
buffer_load_dwordx4 v24, s[48:51], s60 offen offset:0 lds
buffer_load_dwordx4 v25, s[48:51], s60 offen offset:1024 lds
buffer_load_dwordx4 v26, s[48:51], s60 offen offset:2048 lds
buffer_load_dwordx4 v27, s[48:51], s60 offen offset:3072 lds
s_add_u32 m0, s52, 4096
s_add_u32 s60, s60, 28672
buffer_load_dwordx4 v24, s[48:51], s60 offen offset:0 lds
buffer_load_dwordx4 v25, s[48:51], s60 offen offset:1024 lds
buffer_load_dwordx4 v26, s[48:51], s60 offen offset:2048 lds
buffer_load_dwordx4 v27, s[48:51], s60 offen offset:3072 lds
s_waitcnt vmcnt(16)
s_barrier
s_add_u32 m0, s52, 65536
s_mov_b32 s60, s63
s_add_u32 s63, s63, 128
s_cmp_ge_u32 s63, 896
s_cselect_b32 s63, 0, s63
buffer_load_dwordx4 v24, s[48:51], s60 offen offset:0 lds
buffer_load_dwordx4 v25, s[48:51], s60 offen offset:1024 lds
buffer_load_dwordx4 v26, s[48:51], s60 offen offset:2048 lds
buffer_load_dwordx4 v27, s[48:51], s60 offen offset:3072 lds
s_add_u32 m0, s52, 69632
s_add_u32 s60, s60, 28672
buffer_load_dwordx4 v24, s[48:51], s60 offen offset:0 lds
buffer_load_dwordx4 v25, s[48:51], s60 offen offset:1024 lds
buffer_load_dwordx4 v26, s[48:51], s60 offen offset:2048 lds
buffer_load_dwordx4 v27, s[48:51], s60 offen offset:3072 lds
s_waitcnt vmcnt(16)
s_barrier
s_add_u32 m0, s52, 98304
s_mov_b32 s60, s63
s_add_u32 s63, s63, 128
s_cmp_ge_u32 s63, 896
s_cselect_b32 s63, 0, s63
buffer_load_dwordx4 v24, s[48:51], s60 offen offset:0 lds
buffer_load_dwordx4 v25, s[48:51], s60 offen offset:1024 lds
buffer_load_dwordx4 v26, s[48:51], s60 offen offset:2048 lds
buffer_load_dwordx4 v27, s[48:51], s60 offen offset:3072 lds
s_add_u32 m0, s52, 102400
s_add_u32 s60, s60, 28672
buffer_load_dwordx4 v24, s[48:51], s60 offen offset:0 lds
buffer_load_dwordx4 v25, s[48:51], s60 offen offset:1024 lds
buffer_load_dwordx4 v26, s[48:51], s60 offen offset:2048 lds
buffer_load_dwordx4 v27, s[48:51], s60 offen offset:3072 lds
s_waitcnt vmcnt(16)
s_barrier
s_waitcnt vmcnt(8)
s_barrier
s_waitcnt vmcnt(0)
s_barrier
s_endpgm
L_compute:
s_and_b32 s29, s26, 1
s_lshr_b32 s30, s26, 1
v_and_b32 v200, 15, v0
v_lshrrev_b32 v201, 4, v0
v_bfe_u32 v202, v0, 2, 2
v_lshlrev_b32 v194, 4, v0
v_lshrrev_b32 v205, 1, v200
v_xor_b32 v205, v205, v201
v_lshlrev_b32 v205, 4, v205
v_lshl_add_u32 v205, v200, 7, v205
s_lshl_b32 s31, s29, 12
v_add_u32 v192, s31, v205
s_lshl_b32 s31, s30, 12
v_add_u32 v252, s31, v205
v_bfe_u32 v206, v0, 3, 2
v_lshlrev_b32 v206, 1, v206
v_bfe_u32 v207, v0, 1, 1
v_add_u32 v206, v206, v207
s_lshl_b32 s36, s30, 2
v_xor_b32 v206, s36, v206
v_lshlrev_b32 v206, 4, v206
v_and_b32 v207, 1, v0
v_lshl_add_u32 v206, v207, 3, v206
v_lshl_add_u32 v208, v201, 3, v202
v_lshl_add_u32 v193, v208, 7, v206
v_lshl_add_u32 v208, v201, 2, v202
v_lshl_add_u32 v253, v208, 7, v206
v_add_u32 v253, s31, v253
s_lshl_b32 s47, s29, 14
s_add_u32 s47, s47, 65536
s_lshl_b32 s48, s30, 11
s_add_u32 s48, s48, s47
v_add_u32 v216, s47, v194
v_lshrrev_b32 v208, 1, v201
v_lshlrev_b32 v208, 8, v208
v_lshl_add_u32 v208, v200, 4, v208
v_and_b32 v209, 1, v201
v_lshl_add_u32 v208, v209, 3, v208
v_add_u32 v195, s48, v208
s_mov_b32 s38, 0x3db8aa3b
s_mov_b32 s39, 0x41000000
s_mov_b32 s63, 0xffff0000
s_waitcnt lgkmcnt(0)
s_mov_b32 s32, s18
s_mov_b32 s33, s19
s_mov_b32 s34, 14680064
s_mov_b32 s35, 0x20000
s_mov_b32 s52, s14
s_mov_b32 s53, s15
s_mov_b32 s54, 917504
s_mov_b32 s55, 0x20000
s_mul_i32 s45, s25, 56
s_lshl_b32 s46, s26, 1
s_add_u32 s45, s45, s46
s_lshl_b32 s45, s45, 14
s_mul_i32 s87, s25, 2
s_add_u32 s89, s87, s23
s_and_b32 s89, s89, 15
s_lshl_b32 s46, s27, 1
s_lshl_b32 s68, s25, 4
s_lshl_b32 s69, s25, 9
s_add_u32 s69, s69, 15728640
s_lshl_b32 s57, s23, 2
s_add_u32 s57, s57, s69
v_lshl_add_u32 v196, v0, 7, s57
v_mov_b32 v197, 0
s_cmp_lg_u32 s26, 0
s_cbranch_scc1 L_noclr
s_mov_b64 exec, 1
global_store_dword v196, v197, s[18:19] sc0 sc1
s_mov_b64 exec, -1
L_noclr:
s_min_u32 s86, s23, 14
s_cmp_lg_u32 s26, 0
s_cselect_b32 s86, 99, s86
s_add_u32 s88, s68, s23
s_mov_b32 s40, 229440
s_mov_b32 s41, 163904
s_mov_b32 s49, 2
v_xor_b32 v193, 32768, v193
s_barrier
ds_read_b128 v[64:67], v192 offset:0
ds_read_b128 v[68:71], v192 offset:2048
v_xor_b32 v192, 64, v192
ds_read_b128 v[72:75], v192 offset:0
ds_read_b128 v[76:79], v192 offset:2048
ds_read_b64_tr_b16 v[224:225], v193 offset:0
ds_read_b64_tr_b16 v[226:227], v193 offset:512
ds_read_b64_tr_b16 v[228:229], v193 offset:4096
ds_read_b64_tr_b16 v[230:231], v193 offset:4608
ds_read_b64_tr_b16 v[232:233], v193 offset:8192
ds_read_b64_tr_b16 v[234:235], v193 offset:8704
ds_read_b64_tr_b16 v[236:237], v193 offset:12288
ds_read_b64_tr_b16 v[238:239], v193 offset:12800
ds_read_b64_tr_b16 v[240:241], v193 offset:16384
ds_read_b64_tr_b16 v[242:243], v193 offset:16896
ds_read_b64_tr_b16 v[244:245], v193 offset:20480
ds_read_b64_tr_b16 v[246:247], v193 offset:20992
s_waitcnt lgkmcnt(10)
v_mfma_f32_16x16x32_bf16 v[0:3], v[224:227], v[64:67], 0
v_mfma_f32_16x16x32_bf16 v[4:7], v[224:227], v[68:71], 0
s_waitcnt lgkmcnt(8)
ds_read_b64_tr_b16 v[224:225], v193 offset:24576
v_mfma_f32_16x16x32_bf16 v[0:3], v[228:231], v[72:75], v[0:3]
ds_read_b64_tr_b16 v[226:227], v193 offset:25088
v_mfma_f32_16x16x32_bf16 v[4:7], v[228:231], v[76:79], v[4:7]
s_waitcnt lgkmcnt(8)
ds_read_b64_tr_b16 v[228:229], v193 offset:28672
v_mfma_f32_16x16x32_bf16 v[8:11], v[232:235], v[64:67], 0
ds_read_b64_tr_b16 v[230:231], v193 offset:29184
v_xor_b32 v193, 32, v193
v_mfma_f32_16x16x32_bf16 v[12:15], v[232:235], v[68:71], 0
s_waitcnt lgkmcnt(8)
ds_read_b64_tr_b16 v[232:233], v193 offset:0
v_mfma_f32_16x16x32_bf16 v[8:11], v[236:239], v[72:75], v[8:11]
ds_read_b64_tr_b16 v[234:235], v193 offset:512
v_mfma_f32_16x16x32_bf16 v[12:15], v[236:239], v[76:79], v[12:15]
s_waitcnt lgkmcnt(8)
ds_read_b64_tr_b16 v[236:237], v193 offset:4096
v_mfma_f32_16x16x32_bf16 v[16:19], v[240:243], v[64:67], 0
ds_read_b64_tr_b16 v[238:239], v193 offset:4608
v_mfma_f32_16x16x32_bf16 v[20:23], v[240:243], v[68:71], 0
s_waitcnt lgkmcnt(8)
ds_read_b64_tr_b16 v[240:241], v193 offset:8192
v_mfma_f32_16x16x32_bf16 v[16:19], v[244:247], v[72:75], v[16:19]
ds_read_b64_tr_b16 v[242:243], v193 offset:8704
v_mfma_f32_16x16x32_bf16 v[20:23], v[244:247], v[76:79], v[20:23]
s_waitcnt lgkmcnt(8)
ds_read_b64_tr_b16 v[244:245], v193 offset:12288
v_mfma_f32_16x16x32_bf16 v[24:27], v[224:227], v[64:67], 0
ds_read_b64_tr_b16 v[246:247], v193 offset:12800
v_mfma_f32_16x16x32_bf16 v[28:31], v[224:227], v[68:71], 0
s_waitcnt lgkmcnt(8)
ds_read_b64_tr_b16 v[224:225], v193 offset:16384
v_mfma_f32_16x16x32_bf16 v[24:27], v[228:231], v[72:75], v[24:27]
ds_read_b64_tr_b16 v[226:227], v193 offset:16896
v_mfma_f32_16x16x32_bf16 v[28:31], v[228:231], v[76:79], v[28:31]
s_waitcnt lgkmcnt(8)
ds_read_b64_tr_b16 v[228:229], v193 offset:20480
v_mfma_f32_16x16x32_bf16 v[32:35], v[232:235], v[64:67], 0
ds_read_b64_tr_b16 v[230:231], v193 offset:20992
v_mfma_f32_16x16x32_bf16 v[36:39], v[232:235], v[68:71], 0
s_waitcnt lgkmcnt(8)
ds_read_b64_tr_b16 v[232:233], v193 offset:24576
v_mfma_f32_16x16x32_bf16 v[32:35], v[236:239], v[72:75], v[32:35]
ds_read_b64_tr_b16 v[234:235], v193 offset:25088
v_mfma_f32_16x16x32_bf16 v[36:39], v[236:239], v[76:79], v[36:39]
s_waitcnt lgkmcnt(8)
ds_read_b64_tr_b16 v[236:237], v193 offset:28672
v_mfma_f32_16x16x32_bf16 v[40:43], v[240:243], v[64:67], 0
ds_read_b64_tr_b16 v[238:239], v193 offset:29184
v_mfma_f32_16x16x32_bf16 v[44:47], v[240:243], v[68:71], 0
s_waitcnt lgkmcnt(8)
v_mfma_f32_16x16x32_bf16 v[40:43], v[244:247], v[72:75], v[40:43]
v_mfma_f32_16x16x32_bf16 v[44:47], v[244:247], v[76:79], v[44:47]
s_waitcnt lgkmcnt(6)
v_mfma_f32_16x16x32_bf16 v[48:51], v[224:227], v[64:67], 0
v_mfma_f32_16x16x32_bf16 v[52:55], v[224:227], v[68:71], 0
s_waitcnt lgkmcnt(4)
v_mfma_f32_16x16x32_bf16 v[48:51], v[228:231], v[72:75], v[48:51]
v_mfma_f32_16x16x32_bf16 v[52:55], v[228:231], v[76:79], v[52:55]
s_waitcnt lgkmcnt(2)
v_mfma_f32_16x16x32_bf16 v[56:59], v[232:235], v[64:67], 0
v_mfma_f32_16x16x32_bf16 v[60:63], v[232:235], v[68:71], 0
s_waitcnt lgkmcnt(0)
v_mfma_f32_16x16x32_bf16 v[56:59], v[236:239], v[72:75], v[56:59]
v_mfma_f32_16x16x32_bf16 v[60:63], v[236:239], v[76:79], v[60:63]
v_xor_b32 v193, 65536, v193
v_xor_b32 v192, 64, v192
s_barrier
ds_read_b128 v[80:83], v192 offset:8192
ds_read_b128 v[84:87], v192 offset:10240
v_xor_b32 v192, 64, v192
ds_read_b128 v[88:91], v192 offset:8192
ds_read_b128 v[92:95], v192 offset:10240
ds_read_b64_tr_b16 v[224:225], v193 offset:0
ds_read_b64_tr_b16 v[226:227], v193 offset:512
ds_read_b64_tr_b16 v[228:229], v193 offset:4096
ds_read_b64_tr_b16 v[230:231], v193 offset:4608
ds_read_b64_tr_b16 v[232:233], v193 offset:8192
ds_read_b64_tr_b16 v[234:235], v193 offset:8704
ds_read_b64_tr_b16 v[236:237], v193 offset:12288
ds_read_b64_tr_b16 v[238:239], v193 offset:12800
ds_read_b64_tr_b16 v[240:241], v193 offset:16384
ds_read_b64_tr_b16 v[242:243], v193 offset:16896
ds_read_b64_tr_b16 v[244:245], v193 offset:20480
ds_read_b64_tr_b16 v[246:247], v193 offset:20992
s_waitcnt lgkmcnt(10)
v_mfma_f32_16x16x32_bf16 v[32:35], v[224:227], v[80:83], v[32:35]
v_xor_b32 v192, 64, v192
ds_read_b128 v[96:99], v192 offset:16384
v_mfma_f32_16x16x32_bf16 v[36:39], v[224:227], v[84:87], v[36:39]
s_waitcnt lgkmcnt(9)
ds_read_b64_tr_b16 v[224:225], v193 offset:24576
ds_read_b128 v[100:103], v192 offset:18432
v_mfma_f32_16x16x32_bf16 v[32:35], v[228:231], v[88:91], v[32:35]
ds_read_b64_tr_b16 v[226:227], v193 offset:25088
ds_read_b128 v[112:115], v192 offset:24576
v_mfma_f32_16x16x32_bf16 v[36:39], v[228:231], v[92:95], v[36:39]
s_waitcnt lgkmcnt(11)
ds_read_b64_tr_b16 v[228:229], v193 offset:28672
ds_read_b128 v[116:119], v192 offset:26624
v_mfma_f32_16x16x32_bf16 v[40:43], v[232:235], v[80:83], v[40:43]
ds_read_b64_tr_b16 v[230:231], v193 offset:29184
v_xor_b32 v193, 32, v193
v_xor_b32 v192, 64, v192
ds_read_b128 v[104:107], v192 offset:16384
v_mfma_f32_16x16x32_bf16 v[44:47], v[232:235], v[84:87], v[44:47]
s_waitcnt lgkmcnt(13)
ds_read_b64_tr_b16 v[232:233], v193 offset:0
ds_read_b128 v[108:111], v192 offset:18432
v_mfma_f32_16x16x32_bf16 v[40:43], v[236:239], v[88:91], v[40:43]
ds_read_b64_tr_b16 v[234:235], v193 offset:512
ds_read_b128 v[120:123], v192 offset:24576
v_mfma_f32_16x16x32_bf16 v[44:47], v[236:239], v[92:95], v[44:47]
s_waitcnt lgkmcnt(15)
ds_read_b64_tr_b16 v[236:237], v193 offset:4096
ds_read_b128 v[124:127], v192 offset:26624
v_mfma_f32_16x16x32_bf16 v[48:51], v[240:243], v[80:83], v[48:51]
ds_read_b64_tr_b16 v[238:239], v193 offset:4608
v_xor_b32 v192, 65536, v192
ds_read_b128 v[136:139], v192 offset:0
v_mfma_f32_16x16x32_bf16 v[52:55], v[240:243], v[84:87], v[52:55]
s_waitcnt lgkmcnt(15)
ds_read_b64_tr_b16 v[240:241], v193 offset:8192
ds_read_b128 v[140:143], v192 offset:2048
v_mfma_f32_16x16x32_bf16 v[48:51], v[244:247], v[88:91], v[48:51]
ds_read_b64_tr_b16 v[242:243], v193 offset:8704
ds_read_b128 v[152:155], v192 offset:8192
v_mfma_f32_16x16x32_bf16 v[52:55], v[244:247], v[92:95], v[52:55]
s_waitcnt lgkmcnt(15)
ds_read_b64_tr_b16 v[244:245], v193 offset:12288
ds_read_b128 v[156:159], v192 offset:10240
v_mfma_f32_16x16x32_bf16 v[56:59], v[224:227], v[80:83], v[56:59]
ds_read_b64_tr_b16 v[246:247], v193 offset:12800
ds_read_b128 v[168:171], v192 offset:16384
v_mfma_f32_16x16x32_bf16 v[60:63], v[224:227], v[84:87], v[60:63]
s_waitcnt lgkmcnt(15)
ds_read_b64_tr_b16 v[224:225], v193 offset:16384
ds_read_b128 v[172:175], v192 offset:18432
v_mfma_f32_16x16x32_bf16 v[56:59], v[228:231], v[88:91], v[56:59]
ds_read_b64_tr_b16 v[226:227], v193 offset:16896
v_xor_b32 v192, 64, v192
ds_read_b128 v[128:131], v192 offset:0
v_mfma_f32_16x16x32_bf16 v[60:63], v[228:231], v[92:95], v[60:63]
s_waitcnt lgkmcnt(15)
ds_read_b64_tr_b16 v[228:229], v193 offset:20480
ds_read_b128 v[132:135], v192 offset:2048
v_mfma_f32_16x16x32_bf16 v[0:3], v[232:235], v[80:83], v[0:3]
ds_read_b64_tr_b16 v[230:231], v193 offset:20992
ds_read_b128 v[144:147], v192 offset:8192
v_mfma_f32_16x16x32_bf16 v[4:7], v[232:235], v[84:87], v[4:7]
s_waitcnt lgkmcnt(15)
ds_read_b64_tr_b16 v[232:233], v193 offset:24576
ds_read_b128 v[148:151], v192 offset:10240
v_mfma_f32_16x16x32_bf16 v[0:3], v[236:239], v[88:91], v[0:3]
ds_read_b64_tr_b16 v[234:235], v193 offset:25088
ds_read_b128 v[160:163], v192 offset:16384
v_mfma_f32_16x16x32_bf16 v[4:7], v[236:239], v[92:95], v[4:7]
s_waitcnt lgkmcnt(15)
ds_read_b64_tr_b16 v[236:237], v193 offset:28672
ds_read_b128 v[164:167], v192 offset:18432
v_mfma_f32_16x16x32_bf16 v[8:11], v[240:243], v[80:83], v[8:11]
s_waitcnt lgkmcnt(0)
s_barrier
ds_read_b64_tr_b16 v[238:239], v193 offset:29184
v_xor_b32 v193, 229376, v193
v_mfma_f32_16x16x32_bf16 v[12:15], v[240:243], v[84:87], v[12:15]
ds_read_b64_tr_b16 v[240:241], v193 offset:0
v_mfma_f32_16x16x32_bf16 v[8:11], v[244:247], v[88:91], v[8:11]
ds_read_b64_tr_b16 v[242:243], v193 offset:512
v_mfma_f32_16x16x32_bf16 v[12:15], v[244:247], v[92:95], v[12:15]
ds_read_b64_tr_b16 v[244:245], v193 offset:4096
v_mfma_f32_16x16x32_bf16 v[16:19], v[224:227], v[80:83], v[16:19]
ds_read_b64_tr_b16 v[246:247], v193 offset:4608
v_mfma_f32_16x16x32_bf16 v[20:23], v[224:227], v[84:87], v[20:23]
ds_read_b64_tr_b16 v[224:225], v193 offset:8192
v_mfma_f32_16x16x32_bf16 v[16:19], v[228:231], v[88:91], v[16:19]
ds_read_b64_tr_b16 v[226:227], v193 offset:8704
v_mfma_f32_16x16x32_bf16 v[20:23], v[228:231], v[92:95], v[20:23]
ds_read_b64_tr_b16 v[228:229], v193 offset:12288
v_mfma_f32_16x16x32_bf16 v[24:27], v[232:235], v[80:83], v[24:27]
ds_read_b64_tr_b16 v[230:231], v193 offset:12800
v_mfma_f32_16x16x32_bf16 v[28:31], v[232:235], v[84:87], v[28:31]
s_waitcnt lgkmcnt(8)
ds_read_b64_tr_b16 v[232:233], v193 offset:16384
v_mfma_f32_16x16x32_bf16 v[24:27], v[236:239], v[88:91], v[24:27]
ds_read_b64_tr_b16 v[234:235], v193 offset:16896
v_mfma_f32_16x16x32_bf16 v[28:31], v[236:239], v[92:95], v[28:31]
s_waitcnt lgkmcnt(8)
ds_read_b64_tr_b16 v[236:237], v193 offset:20480
v_mfma_f32_16x16x32_bf16 v[0:3], v[240:243], v[96:99], v[0:3]
ds_read_b64_tr_b16 v[238:239], v193 offset:20992
v_mfma_f32_16x16x32_bf16 v[4:7], v[240:243], v[100:103], v[4:7]
s_waitcnt lgkmcnt(8)
ds_read_b64_tr_b16 v[240:241], v193 offset:24576
v_mfma_f32_16x16x32_bf16 v[0:3], v[244:247], v[104:107], v[0:3]
ds_read_b64_tr_b16 v[242:243], v193 offset:25088
v_mfma_f32_16x16x32_bf16 v[4:7], v[244:247], v[108:111], v[4:7]
s_waitcnt lgkmcnt(8)
ds_read_b64_tr_b16 v[244:245], v193 offset:28672
v_mfma_f32_16x16x32_bf16 v[8:11], v[224:227], v[96:99], v[8:11]
ds_read_b64_tr_b16 v[246:247], v193 offset:29184
v_xor_b32 v193, 32, v193
v_mfma_f32_16x16x32_bf16 v[12:15], v[224:227], v[100:103], v[12:15]
s_waitcnt lgkmcnt(8)
ds_read_b64_tr_b16 v[224:225], v193 offset:0
v_mfma_f32_16x16x32_bf16 v[8:11], v[228:231], v[104:107], v[8:11]
ds_read_b64_tr_b16 v[226:227], v193 offset:512
v_mfma_f32_16x16x32_bf16 v[12:15], v[228:231], v[108:111], v[12:15]
s_waitcnt lgkmcnt(8)
ds_read_b64_tr_b16 v[228:229], v193 offset:4096
v_mfma_f32_16x16x32_bf16 v[16:19], v[232:235], v[96:99], v[16:19]
ds_read_b64_tr_b16 v[230:231], v193 offset:4608
v_mfma_f32_16x16x32_bf16 v[20:23], v[232:235], v[100:103], v[20:23]
s_waitcnt lgkmcnt(8)
ds_read_b64_tr_b16 v[232:233], v193 offset:8192
v_mfma_f32_16x16x32_bf16 v[16:19], v[236:239], v[104:107], v[16:19]
ds_read_b64_tr_b16 v[234:235], v193 offset:8704
v_mfma_f32_16x16x32_bf16 v[20:23], v[236:239], v[108:111], v[20:23]
s_waitcnt lgkmcnt(8)
ds_read_b64_tr_b16 v[236:237], v193 offset:12288
v_mfma_f32_16x16x32_bf16 v[24:27], v[240:243], v[96:99], v[24:27]
ds_read_b64_tr_b16 v[238:239], v193 offset:12800
v_mfma_f32_16x16x32_bf16 v[28:31], v[240:243], v[100:103], v[28:31]
s_waitcnt lgkmcnt(8)
ds_read_b64_tr_b16 v[240:241], v193 offset:16384
v_mfma_f32_16x16x32_bf16 v[24:27], v[244:247], v[104:107], v[24:27]
ds_read_b64_tr_b16 v[242:243], v193 offset:16896
v_mfma_f32_16x16x32_bf16 v[28:31], v[244:247], v[108:111], v[28:31]
s_waitcnt lgkmcnt(8)
ds_read_b64_tr_b16 v[244:245], v193 offset:20480
v_mfma_f32_16x16x32_bf16 v[32:35], v[224:227], v[96:99], v[32:35]
ds_read_b64_tr_b16 v[246:247], v193 offset:20992
v_mfma_f32_16x16x32_bf16 v[36:39], v[224:227], v[100:103], v[36:39]
s_waitcnt lgkmcnt(8)
ds_read_b64_tr_b16 v[224:225], v193 offset:24576
v_mfma_f32_16x16x32_bf16 v[32:35], v[228:231], v[104:107], v[32:35]
ds_read_b64_tr_b16 v[226:227], v193 offset:25088
v_mfma_f32_16x16x32_bf16 v[36:39], v[228:231], v[108:111], v[36:39]
s_waitcnt lgkmcnt(8)
ds_read_b64_tr_b16 v[228:229], v193 offset:28672
v_mfma_f32_16x16x32_bf16 v[40:43], v[232:235], v[96:99], v[40:43]
s_barrier
ds_read_b64_tr_b16 v[230:231], v193 offset:29184
v_xor_b32 v193, 163840, v193
v_mfma_f32_16x16x32_bf16 v[44:47], v[232:235], v[100:103], v[44:47]
s_waitcnt lgkmcnt(8)
ds_read_b64_tr_b16 v[232:233], v193 offset:0
v_mfma_f32_16x16x32_bf16 v[40:43], v[236:239], v[104:107], v[40:43]
ds_read_b64_tr_b16 v[234:235], v193 offset:512
v_mfma_f32_16x16x32_bf16 v[44:47], v[236:239], v[108:111], v[44:47]
s_waitcnt lgkmcnt(8)
ds_read_b64_tr_b16 v[236:237], v193 offset:4096
v_mfma_f32_16x16x32_bf16 v[48:51], v[240:243], v[96:99], v[48:51]
ds_read_b64_tr_b16 v[238:239], v193 offset:4608
v_mfma_f32_16x16x32_bf16 v[52:55], v[240:243], v[100:103], v[52:55]
s_waitcnt lgkmcnt(8)
ds_read_b64_tr_b16 v[240:241], v193 offset:8192
v_mfma_f32_16x16x32_bf16 v[48:51], v[244:247], v[104:107], v[48:51]
ds_read_b64_tr_b16 v[242:243], v193 offset:8704
v_mfma_f32_16x16x32_bf16 v[52:55], v[244:247], v[108:111], v[52:55]
s_waitcnt lgkmcnt(8)
ds_read_b64_tr_b16 v[244:245], v193 offset:12288
v_mfma_f32_16x16x32_bf16 v[56:59], v[224:227], v[96:99], v[56:59]
ds_read_b64_tr_b16 v[246:247], v193 offset:12800
v_mfma_f32_16x16x32_bf16 v[60:63], v[224:227], v[100:103], v[60:63]
s_waitcnt lgkmcnt(8)
ds_read_b64_tr_b16 v[224:225], v193 offset:16384
v_mfma_f32_16x16x32_bf16 v[56:59], v[228:231], v[104:107], v[56:59]
ds_read_b64_tr_b16 v[226:227], v193 offset:16896
v_mfma_f32_16x16x32_bf16 v[60:63], v[228:231], v[108:111], v[60:63]
s_waitcnt lgkmcnt(8)
ds_read_b64_tr_b16 v[228:229], v193 offset:20480
v_mfma_f32_16x16x32_bf16 v[32:35], v[232:235], v[112:115], v[32:35]
ds_read_b64_tr_b16 v[230:231], v193 offset:20992
v_mfma_f32_16x16x32_bf16 v[36:39], v[232:235], v[116:119], v[36:39]
s_waitcnt lgkmcnt(8)
ds_read_b64_tr_b16 v[232:233], v193 offset:24576
v_mfma_f32_16x16x32_bf16 v[32:35], v[236:239], v[120:123], v[32:35]
ds_read_b64_tr_b16 v[234:235], v193 offset:25088
v_mfma_f32_16x16x32_bf16 v[36:39], v[236:239], v[124:127], v[36:39]
s_waitcnt lgkmcnt(8)
ds_read_b64_tr_b16 v[236:237], v193 offset:28672
v_mfma_f32_16x16x32_bf16 v[40:43], v[240:243], v[112:115], v[40:43]
ds_read_b64_tr_b16 v[238:239], v193 offset:29184
v_xor_b32 v193, 32, v193
v_mfma_f32_16x16x32_bf16 v[44:47], v[240:243], v[116:119], v[44:47]
s_waitcnt lgkmcnt(8)
ds_read_b64_tr_b16 v[240:241], v193 offset:0
v_mfma_f32_16x16x32_bf16 v[40:43], v[244:247], v[120:123], v[40:43]
ds_read_b64_tr_b16 v[242:243], v193 offset:512
v_mfma_f32_16x16x32_bf16 v[44:47], v[244:247], v[124:127], v[44:47]
s_waitcnt lgkmcnt(8)
ds_read_b64_tr_b16 v[244:245], v193 offset:4096
v_mfma_f32_16x16x32_bf16 v[48:51], v[224:227], v[112:115], v[48:51]
ds_read_b64_tr_b16 v[246:247], v193 offset:4608
v_mfma_f32_16x16x32_bf16 v[52:55], v[224:227], v[116:119], v[52:55]
s_waitcnt lgkmcnt(8)
ds_read_b64_tr_b16 v[224:225], v193 offset:8192
v_mfma_f32_16x16x32_bf16 v[48:51], v[228:231], v[120:123], v[48:51]
ds_read_b64_tr_b16 v[226:227], v193 offset:8704
v_mfma_f32_16x16x32_bf16 v[52:55], v[228:231], v[124:127], v[52:55]
s_waitcnt lgkmcnt(8)
ds_read_b64_tr_b16 v[228:229], v193 offset:12288
v_mfma_f32_16x16x32_bf16 v[56:59], v[232:235], v[112:115], v[56:59]
ds_read_b64_tr_b16 v[230:231], v193 offset:12800
v_mfma_f32_16x16x32_bf16 v[60:63], v[232:235], v[116:119], v[60:63]
s_waitcnt lgkmcnt(8)
ds_read_b64_tr_b16 v[232:233], v193 offset:16384
v_mfma_f32_16x16x32_bf16 v[56:59], v[236:239], v[120:123], v[56:59]
ds_read_b64_tr_b16 v[234:235], v193 offset:16896
v_mfma_f32_16x16x32_bf16 v[60:63], v[236:239], v[124:127], v[60:63]
s_waitcnt lgkmcnt(8)
ds_read_b64_tr_b16 v[236:237], v193 offset:20480
v_mfma_f32_16x16x32_bf16 v[0:3], v[240:243], v[112:115], v[0:3]
ds_read_b64_tr_b16 v[238:239], v193 offset:20992
v_mfma_f32_16x16x32_bf16 v[4:7], v[240:243], v[116:119], v[4:7]
s_waitcnt lgkmcnt(8)
ds_read_b64_tr_b16 v[240:241], v193 offset:24576
v_mfma_f32_16x16x32_bf16 v[0:3], v[244:247], v[120:123], v[0:3]
ds_read_b64_tr_b16 v[242:243], v193 offset:25088
v_mfma_f32_16x16x32_bf16 v[4:7], v[244:247], v[124:127], v[4:7]
s_waitcnt lgkmcnt(8)
ds_read_b64_tr_b16 v[244:245], v193 offset:28672
v_mfma_f32_16x16x32_bf16 v[8:11], v[224:227], v[112:115], v[8:11]
s_barrier
ds_read_b64_tr_b16 v[246:247], v193 offset:29184
v_xor_b32 v193, 32768, v193
v_mfma_f32_16x16x32_bf16 v[12:15], v[224:227], v[116:119], v[12:15]
s_waitcnt lgkmcnt(8)
ds_read_b64_tr_b16 v[224:225], v193 offset:0
v_mfma_f32_16x16x32_bf16 v[8:11], v[228:231], v[120:123], v[8:11]
ds_read_b64_tr_b16 v[226:227], v193 offset:512
v_mfma_f32_16x16x32_bf16 v[12:15], v[228:231], v[124:127], v[12:15]
s_waitcnt lgkmcnt(8)
ds_read_b64_tr_b16 v[228:229], v193 offset:4096
v_mfma_f32_16x16x32_bf16 v[16:19], v[232:235], v[112:115], v[16:19]
ds_read_b64_tr_b16 v[230:231], v193 offset:4608
v_mfma_f32_16x16x32_bf16 v[20:23], v[232:235], v[116:119], v[20:23]
s_waitcnt lgkmcnt(8)
ds_read_b64_tr_b16 v[232:233], v193 offset:8192
v_mfma_f32_16x16x32_bf16 v[16:19], v[236:239], v[120:123], v[16:19]
ds_read_b64_tr_b16 v[234:235], v193 offset:8704
v_mfma_f32_16x16x32_bf16 v[20:23], v[236:239], v[124:127], v[20:23]
s_waitcnt lgkmcnt(8)
ds_read_b64_tr_b16 v[236:237], v193 offset:12288
v_mfma_f32_16x16x32_bf16 v[24:27], v[240:243], v[112:115], v[24:27]
ds_read_b64_tr_b16 v[238:239], v193 offset:12800
v_mfma_f32_16x16x32_bf16 v[28:31], v[240:243], v[116:119], v[28:31]
s_waitcnt lgkmcnt(8)
ds_read_b64_tr_b16 v[240:241], v193 offset:16384
v_mfma_f32_16x16x32_bf16 v[24:27], v[244:247], v[120:123], v[24:27]
ds_read_b64_tr_b16 v[242:243], v193 offset:16896
v_mfma_f32_16x16x32_bf16 v[28:31], v[244:247], v[124:127], v[28:31]
s_waitcnt lgkmcnt(8)
ds_read_b64_tr_b16 v[244:245], v193 offset:20480
v_mfma_f32_16x16x32_bf16 v[0:3], v[224:227], v[128:131], v[0:3]
ds_read_b64_tr_b16 v[246:247], v193 offset:20992
v_mfma_f32_16x16x32_bf16 v[4:7], v[224:227], v[132:135], v[4:7]
s_waitcnt lgkmcnt(8)
ds_read_b64_tr_b16 v[224:225], v193 offset:24576
v_mfma_f32_16x16x32_bf16 v[0:3], v[228:231], v[136:139], v[0:3]
ds_read_b64_tr_b16 v[226:227], v193 offset:25088
v_mfma_f32_16x16x32_bf16 v[4:7], v[228:231], v[140:143], v[4:7]
s_waitcnt lgkmcnt(8)
ds_read_b64_tr_b16 v[228:229], v193 offset:28672
v_mfma_f32_16x16x32_bf16 v[8:11], v[232:235], v[128:131], v[8:11]
ds_read_b64_tr_b16 v[230:231], v193 offset:29184
v_xor_b32 v193, 32, v193
v_mfma_f32_16x16x32_bf16 v[12:15], v[232:235], v[132:135], v[12:15]
s_waitcnt lgkmcnt(8)
ds_read_b64_tr_b16 v[232:233], v193 offset:0
v_mfma_f32_16x16x32_bf16 v[8:11], v[236:239], v[136:139], v[8:11]
ds_read_b64_tr_b16 v[234:235], v193 offset:512
v_mfma_f32_16x16x32_bf16 v[12:15], v[236:239], v[140:143], v[12:15]
s_waitcnt lgkmcnt(8)
ds_read_b64_tr_b16 v[236:237], v193 offset:4096
v_mfma_f32_16x16x32_bf16 v[16:19], v[240:243], v[128:131], v[16:19]
ds_read_b64_tr_b16 v[238:239], v193 offset:4608
v_mfma_f32_16x16x32_bf16 v[20:23], v[240:243], v[132:135], v[20:23]
s_waitcnt lgkmcnt(8)
ds_read_b64_tr_b16 v[240:241], v193 offset:8192
v_mfma_f32_16x16x32_bf16 v[16:19], v[244:247], v[136:139], v[16:19]
ds_read_b64_tr_b16 v[242:243], v193 offset:8704
v_mfma_f32_16x16x32_bf16 v[20:23], v[244:247], v[140:143], v[20:23]
s_waitcnt lgkmcnt(8)
ds_read_b64_tr_b16 v[244:245], v193 offset:12288
v_mfma_f32_16x16x32_bf16 v[24:27], v[224:227], v[128:131], v[24:27]
ds_read_b64_tr_b16 v[246:247], v193 offset:12800
v_mfma_f32_16x16x32_bf16 v[28:31], v[224:227], v[132:135], v[28:31]
s_waitcnt lgkmcnt(8)
ds_read_b64_tr_b16 v[224:225], v193 offset:16384
v_mfma_f32_16x16x32_bf16 v[24:27], v[228:231], v[136:139], v[24:27]
ds_read_b64_tr_b16 v[226:227], v193 offset:16896
v_mfma_f32_16x16x32_bf16 v[28:31], v[228:231], v[140:143], v[28:31]
s_waitcnt lgkmcnt(8)
ds_read_b64_tr_b16 v[228:229], v193 offset:20480
v_mfma_f32_16x16x32_bf16 v[32:35], v[232:235], v[128:131], v[32:35]
ds_read_b64_tr_b16 v[230:231], v193 offset:20992
v_mfma_f32_16x16x32_bf16 v[36:39], v[232:235], v[132:135], v[36:39]
s_waitcnt lgkmcnt(8)
ds_read_b64_tr_b16 v[232:233], v193 offset:24576
v_mfma_f32_16x16x32_bf16 v[32:35], v[236:239], v[136:139], v[32:35]
ds_read_b64_tr_b16 v[234:235], v193 offset:25088
v_mfma_f32_16x16x32_bf16 v[36:39], v[236:239], v[140:143], v[36:39]
s_waitcnt lgkmcnt(8)
ds_read_b64_tr_b16 v[236:237], v193 offset:28672
v_mfma_f32_16x16x32_bf16 v[40:43], v[240:243], v[128:131], v[40:43]
s_barrier
ds_read_b64_tr_b16 v[238:239], v193 offset:29184
v_xor_b32 v193, 65536, v193
v_mfma_f32_16x16x32_bf16 v[44:47], v[240:243], v[132:135], v[44:47]
s_waitcnt lgkmcnt(8)
ds_read_b64_tr_b16 v[240:241], v193 offset:0
v_mfma_f32_16x16x32_bf16 v[40:43], v[244:247], v[136:139], v[40:43]
ds_read_b64_tr_b16 v[242:243], v193 offset:512
v_mfma_f32_16x16x32_bf16 v[44:47], v[244:247], v[140:143], v[44:47]
s_waitcnt lgkmcnt(8)
ds_read_b64_tr_b16 v[244:245], v193 offset:4096
v_mfma_f32_16x16x32_bf16 v[48:51], v[224:227], v[128:131], v[48:51]
ds_read_b64_tr_b16 v[246:247], v193 offset:4608
v_mfma_f32_16x16x32_bf16 v[52:55], v[224:227], v[132:135], v[52:55]
s_waitcnt lgkmcnt(8)
ds_read_b64_tr_b16 v[224:225], v193 offset:8192
v_mfma_f32_16x16x32_bf16 v[48:51], v[228:231], v[136:139], v[48:51]
ds_read_b64_tr_b16 v[226:227], v193 offset:8704
v_mfma_f32_16x16x32_bf16 v[52:55], v[228:231], v[140:143], v[52:55]
s_waitcnt lgkmcnt(8)
ds_read_b64_tr_b16 v[228:229], v193 offset:12288
v_mfma_f32_16x16x32_bf16 v[56:59], v[232:235], v[128:131], v[56:59]
ds_read_b64_tr_b16 v[230:231], v193 offset:12800
v_mfma_f32_16x16x32_bf16 v[60:63], v[232:235], v[132:135], v[60:63]
s_waitcnt lgkmcnt(8)
ds_read_b64_tr_b16 v[232:233], v193 offset:16384
v_mfma_f32_16x16x32_bf16 v[56:59], v[236:239], v[136:139], v[56:59]
ds_read_b64_tr_b16 v[234:235], v193 offset:16896
v_mfma_f32_16x16x32_bf16 v[60:63], v[236:239], v[140:143], v[60:63]
s_waitcnt lgkmcnt(8)
ds_read_b64_tr_b16 v[236:237], v193 offset:20480
v_mfma_f32_16x16x32_bf16 v[32:35], v[240:243], v[144:147], v[32:35]
ds_read_b64_tr_b16 v[238:239], v193 offset:20992
v_mfma_f32_16x16x32_bf16 v[36:39], v[240:243], v[148:151], v[36:39]
s_waitcnt lgkmcnt(8)
ds_read_b64_tr_b16 v[240:241], v193 offset:24576
v_mfma_f32_16x16x32_bf16 v[32:35], v[244:247], v[152:155], v[32:35]
ds_read_b64_tr_b16 v[242:243], v193 offset:25088
v_mfma_f32_16x16x32_bf16 v[36:39], v[244:247], v[156:159], v[36:39]
s_waitcnt lgkmcnt(8)
ds_read_b64_tr_b16 v[244:245], v193 offset:28672
v_mfma_f32_16x16x32_bf16 v[40:43], v[224:227], v[144:147], v[40:43]
ds_read_b64_tr_b16 v[246:247], v193 offset:29184
v_xor_b32 v193, 32, v193
v_mfma_f32_16x16x32_bf16 v[44:47], v[224:227], v[148:151], v[44:47]
s_waitcnt lgkmcnt(8)
ds_read_b64_tr_b16 v[224:225], v193 offset:0
v_mfma_f32_16x16x32_bf16 v[40:43], v[228:231], v[152:155], v[40:43]
ds_read_b64_tr_b16 v[226:227], v193 offset:512
v_mfma_f32_16x16x32_bf16 v[44:47], v[228:231], v[156:159], v[44:47]
s_waitcnt lgkmcnt(8)
ds_read_b64_tr_b16 v[228:229], v193 offset:4096
v_mfma_f32_16x16x32_bf16 v[48:51], v[232:235], v[144:147], v[48:51]
ds_read_b64_tr_b16 v[230:231], v193 offset:4608
v_mfma_f32_16x16x32_bf16 v[52:55], v[232:235], v[148:151], v[52:55]
s_waitcnt lgkmcnt(8)
ds_read_b64_tr_b16 v[232:233], v193 offset:8192
v_mfma_f32_16x16x32_bf16 v[48:51], v[236:239], v[152:155], v[48:51]
ds_read_b64_tr_b16 v[234:235], v193 offset:8704
v_mfma_f32_16x16x32_bf16 v[52:55], v[236:239], v[156:159], v[52:55]
s_waitcnt lgkmcnt(8)
ds_read_b64_tr_b16 v[236:237], v193 offset:12288
v_mfma_f32_16x16x32_bf16 v[56:59], v[240:243], v[144:147], v[56:59]
ds_read_b64_tr_b16 v[238:239], v193 offset:12800
v_mfma_f32_16x16x32_bf16 v[60:63], v[240:243], v[148:151], v[60:63]
s_waitcnt lgkmcnt(8)
ds_read_b64_tr_b16 v[240:241], v193 offset:16384
v_mfma_f32_16x16x32_bf16 v[56:59], v[244:247], v[152:155], v[56:59]
ds_read_b64_tr_b16 v[242:243], v193 offset:16896
v_mfma_f32_16x16x32_bf16 v[60:63], v[244:247], v[156:159], v[60:63]
s_waitcnt lgkmcnt(8)
ds_read_b64_tr_b16 v[244:245], v193 offset:20480
v_mfma_f32_16x16x32_bf16 v[0:3], v[224:227], v[144:147], v[0:3]
ds_read_b64_tr_b16 v[246:247], v193 offset:20992
v_mfma_f32_16x16x32_bf16 v[4:7], v[224:227], v[148:151], v[4:7]
s_waitcnt lgkmcnt(8)
ds_read_b64_tr_b16 v[224:225], v193 offset:24576
v_mfma_f32_16x16x32_bf16 v[0:3], v[228:231], v[152:155], v[0:3]
ds_read_b64_tr_b16 v[226:227], v193 offset:25088
v_mfma_f32_16x16x32_bf16 v[4:7], v[228:231], v[156:159], v[4:7]
s_waitcnt lgkmcnt(8)
ds_read_b64_tr_b16 v[228:229], v193 offset:28672
v_mfma_f32_16x16x32_bf16 v[8:11], v[232:235], v[144:147], v[8:11]
s_barrier
ds_read_b64_tr_b16 v[230:231], v193 offset:29184
v_xor_b32 v193, 32768, v193
v_mfma_f32_16x16x32_bf16 v[12:15], v[232:235], v[148:151], v[12:15]
s_waitcnt lgkmcnt(8)
ds_read_b64_tr_b16 v[232:233], v193 offset:0
v_mfma_f32_16x16x32_bf16 v[8:11], v[236:239], v[152:155], v[8:11]
ds_read_b64_tr_b16 v[234:235], v193 offset:512
v_mfma_f32_16x16x32_bf16 v[12:15], v[236:239], v[156:159], v[12:15]
s_waitcnt lgkmcnt(8)
ds_read_b64_tr_b16 v[236:237], v193 offset:4096
v_mfma_f32_16x16x32_bf16 v[16:19], v[240:243], v[144:147], v[16:19]
ds_read_b64_tr_b16 v[238:239], v193 offset:4608
v_mfma_f32_16x16x32_bf16 v[20:23], v[240:243], v[148:151], v[20:23]
s_waitcnt lgkmcnt(8)
ds_read_b64_tr_b16 v[240:241], v193 offset:8192
v_mfma_f32_16x16x32_bf16 v[16:19], v[244:247], v[152:155], v[16:19]
ds_read_b64_tr_b16 v[242:243], v193 offset:8704
v_mfma_f32_16x16x32_bf16 v[20:23], v[244:247], v[156:159], v[20:23]
s_waitcnt lgkmcnt(8)
ds_read_b64_tr_b16 v[244:245], v193 offset:12288
v_mfma_f32_16x16x32_bf16 v[24:27], v[224:227], v[144:147], v[24:27]
ds_read_b64_tr_b16 v[246:247], v193 offset:12800
v_mfma_f32_16x16x32_bf16 v[28:31], v[224:227], v[148:151], v[28:31]
s_waitcnt lgkmcnt(8)
ds_read_b64_tr_b16 v[224:225], v193 offset:16384
v_mfma_f32_16x16x32_bf16 v[24:27], v[228:231], v[152:155], v[24:27]
ds_read_b64_tr_b16 v[226:227], v193 offset:16896
v_mfma_f32_16x16x32_bf16 v[28:31], v[228:231], v[156:159], v[28:31]
s_waitcnt lgkmcnt(8)
ds_read_b64_tr_b16 v[228:229], v193 offset:20480
v_mfma_f32_16x16x32_bf16 v[0:3], v[232:235], v[160:163], v[0:3]
ds_read_b64_tr_b16 v[230:231], v193 offset:20992
v_mfma_f32_16x16x32_bf16 v[4:7], v[232:235], v[164:167], v[4:7]
s_waitcnt lgkmcnt(8)
ds_read_b64_tr_b16 v[232:233], v193 offset:24576
v_mfma_f32_16x16x32_bf16 v[0:3], v[236:239], v[168:171], v[0:3]
ds_read_b64_tr_b16 v[234:235], v193 offset:25088
v_mfma_f32_16x16x32_bf16 v[4:7], v[236:239], v[172:175], v[4:7]
s_waitcnt lgkmcnt(8)
ds_read_b64_tr_b16 v[236:237], v193 offset:28672
v_mfma_f32_16x16x32_bf16 v[8:11], v[240:243], v[160:163], v[8:11]
ds_read_b64_tr_b16 v[238:239], v193 offset:29184
v_xor_b32 v193, 32, v193
v_mfma_f32_16x16x32_bf16 v[12:15], v[240:243], v[164:167], v[12:15]
s_waitcnt lgkmcnt(8)
ds_read_b64_tr_b16 v[240:241], v193 offset:0
v_mfma_f32_16x16x32_bf16 v[8:11], v[244:247], v[168:171], v[8:11]
ds_read_b64_tr_b16 v[242:243], v193 offset:512
v_mfma_f32_16x16x32_bf16 v[12:15], v[244:247], v[172:175], v[12:15]
s_waitcnt lgkmcnt(8)
ds_read_b64_tr_b16 v[244:245], v193 offset:4096
v_mfma_f32_16x16x32_bf16 v[16:19], v[224:227], v[160:163], v[16:19]
ds_read_b64_tr_b16 v[246:247], v193 offset:4608
v_pk_mul_f32 v[0:1], v[0:1], s[38:39] op_sel_hi:[1,0]
v_mfma_f32_16x16x32_bf16 v[20:23], v[224:227], v[164:167], v[20:23]
s_waitcnt lgkmcnt(8)
ds_read_b64_tr_b16 v[224:225], v193 offset:8192
v_pk_mul_f32 v[2:3], v[2:3], s[38:39] op_sel_hi:[1,0]
v_mfma_f32_16x16x32_bf16 v[16:19], v[228:231], v[168:171], v[16:19]
ds_read_b64_tr_b16 v[226:227], v193 offset:8704
v_cvt_pk_bf16_f32 v0, v0, v1
v_mfma_f32_16x16x32_bf16 v[20:23], v[228:231], v[172:175], v[20:23]
s_waitcnt lgkmcnt(8)
ds_read_b64_tr_b16 v[228:229], v193 offset:12288
v_cvt_pk_bf16_f32 v1, v2, v3
v_mfma_f32_16x16x32_bf16 v[24:27], v[232:235], v[160:163], v[24:27]
ds_read_b64_tr_b16 v[230:231], v193 offset:12800
v_pk_mul_f32 v[4:5], v[4:5], s[38:39] op_sel_hi:[1,0]
v_mfma_f32_16x16x32_bf16 v[28:31], v[232:235], v[164:167], v[28:31]
s_waitcnt lgkmcnt(8)
ds_read_b64_tr_b16 v[232:233], v193 offset:16384
v_pk_mul_f32 v[6:7], v[6:7], s[38:39] op_sel_hi:[1,0]
v_mfma_f32_16x16x32_bf16 v[24:27], v[236:239], v[168:171], v[24:27]
ds_read_b64_tr_b16 v[234:235], v193 offset:16896
v_cvt_pk_bf16_f32 v4, v4, v5
v_mfma_f32_16x16x32_bf16 v[28:31], v[236:239], v[172:175], v[28:31]
s_waitcnt lgkmcnt(8)
ds_read_b64_tr_b16 v[236:237], v193 offset:20480
v_cvt_pk_bf16_f32 v5, v6, v7
v_mfma_f32_16x16x32_bf16 v[32:35], v[240:243], v[160:163], v[32:35]
ds_read_b64_tr_b16 v[238:239], v193 offset:20992
v_pk_mul_f32 v[8:9], v[8:9], s[38:39] op_sel_hi:[1,0]
v_mfma_f32_16x16x32_bf16 v[36:39], v[240:243], v[164:167], v[36:39]
s_waitcnt lgkmcnt(8)
ds_read_b64_tr_b16 v[240:241], v193 offset:24576
v_pk_mul_f32 v[10:11], v[10:11], s[38:39] op_sel_hi:[1,0]
v_mfma_f32_16x16x32_bf16 v[32:35], v[244:247], v[168:171], v[32:35]
ds_read_b64_tr_b16 v[242:243], v193 offset:25088
v_cvt_pk_bf16_f32 v8, v8, v9
v_mfma_f32_16x16x32_bf16 v[36:39], v[244:247], v[172:175], v[36:39]
s_waitcnt lgkmcnt(8)
ds_read_b64_tr_b16 v[244:245], v193 offset:28672
v_cvt_pk_bf16_f32 v9, v10, v11
v_mfma_f32_16x16x32_bf16 v[40:43], v[224:227], v[160:163], v[40:43]
s_barrier
ds_read_b64_tr_b16 v[246:247], v193 offset:29184
v_pk_mul_f32 v[12:13], v[12:13], s[38:39] op_sel_hi:[1,0]
v_mfma_f32_16x16x32_bf16 v[44:47], v[224:227], v[164:167], v[44:47]
s_waitcnt lgkmcnt(8)
v_pk_mul_f32 v[14:15], v[14:15], s[38:39] op_sel_hi:[1,0]
v_cvt_pk_bf16_f32 v12, v12, v13
v_mfma_f32_16x16x32_bf16 v[40:43], v[228:231], v[168:171], v[40:43]
v_cvt_pk_bf16_f32 v13, v14, v15
v_pk_mul_f32 v[16:17], v[16:17], s[38:39] op_sel_hi:[1,0]
v_mfma_f32_16x16x32_bf16 v[44:47], v[228:231], v[172:175], v[44:47]
s_waitcnt lgkmcnt(6)
v_pk_mul_f32 v[18:19], v[18:19], s[38:39] op_sel_hi:[1,0]
v_cvt_pk_bf16_f32 v16, v16, v17
v_mfma_f32_16x16x32_bf16 v[48:51], v[232:235], v[160:163], v[48:51]
v_cvt_pk_bf16_f32 v17, v18, v19
v_pk_mul_f32 v[20:21], v[20:21], s[38:39] op_sel_hi:[1,0]
v_mfma_f32_16x16x32_bf16 v[52:55], v[232:235], v[164:167], v[52:55]
s_waitcnt lgkmcnt(4)
v_pk_mul_f32 v[22:23], v[22:23], s[38:39] op_sel_hi:[1,0]
v_cvt_pk_bf16_f32 v20, v20, v21
v_mfma_f32_16x16x32_bf16 v[48:51], v[236:239], v[168:171], v[48:51]
v_cvt_pk_bf16_f32 v21, v22, v23
v_pk_mul_f32 v[24:25], v[24:25], s[38:39] op_sel_hi:[1,0]
v_mfma_f32_16x16x32_bf16 v[52:55], v[236:239], v[172:175], v[52:55]
s_waitcnt lgkmcnt(2)
v_pk_mul_f32 v[26:27], v[26:27], s[38:39] op_sel_hi:[1,0]
v_cvt_pk_bf16_f32 v24, v24, v25
v_mfma_f32_16x16x32_bf16 v[56:59], v[240:243], v[160:163], v[56:59]
v_cvt_pk_bf16_f32 v25, v26, v27
v_pk_mul_f32 v[28:29], v[28:29], s[38:39] op_sel_hi:[1,0]
v_mfma_f32_16x16x32_bf16 v[60:63], v[240:243], v[164:167], v[60:63]
s_waitcnt lgkmcnt(0)
v_pk_mul_f32 v[30:31], v[30:31], s[38:39] op_sel_hi:[1,0]
v_cvt_pk_bf16_f32 v28, v28, v29
v_mfma_f32_16x16x32_bf16 v[56:59], v[244:247], v[168:171], v[56:59]
v_cvt_pk_bf16_f32 v29, v30, v31
v_pk_mul_f32 v[32:33], v[32:33], s[38:39] op_sel_hi:[1,0]
v_mfma_f32_16x16x32_bf16 v[60:63], v[244:247], v[172:175], v[60:63]
v_pk_mul_f32 v[34:35], v[34:35], s[38:39] op_sel_hi:[1,0]
v_cvt_pk_bf16_f32 v32, v32, v33
v_xor_b32 v252, 131072, v252
ds_write_b64 v195, v[0:1] offset:0
ds_write_b64 v195, v[4:5] offset:1024
ds_write_b64 v195, v[8:9] offset:4096
ds_write_b64 v195, v[12:13] offset:5120
ds_write_b64 v195, v[16:17] offset:8192
ds_write_b64 v195, v[20:21] offset:9216
ds_write_b64 v195, v[24:25] offset:12288
ds_write_b64 v195, v[28:29] offset:13312
v_cvt_pk_bf16_f32 v33, v34, v35
v_pk_mul_f32 v[36:37], v[36:37], s[38:39] op_sel_hi:[1,0]
v_pk_mul_f32 v[38:39], v[38:39], s[38:39] op_sel_hi:[1,0]
v_cvt_pk_bf16_f32 v36, v36, v37
v_cvt_pk_bf16_f32 v37, v38, v39
ds_write_b64 v195, v[32:33] offset:512
ds_write_b64 v195, v[36:37] offset:1536
v_pk_mul_f32 v[40:41], v[40:41], s[38:39] op_sel_hi:[1,0]
v_pk_mul_f32 v[42:43], v[42:43], s[38:39] op_sel_hi:[1,0]
v_cvt_pk_bf16_f32 v40, v40, v41
v_cvt_pk_bf16_f32 v41, v42, v43
v_pk_mul_f32 v[44:45], v[44:45], s[38:39] op_sel_hi:[1,0]
v_pk_mul_f32 v[46:47], v[46:47], s[38:39] op_sel_hi:[1,0]
v_cvt_pk_bf16_f32 v44, v44, v45
v_cvt_pk_bf16_f32 v45, v46, v47
ds_write_b64 v195, v[40:41] offset:4608
ds_write_b64 v195, v[44:45] offset:5632
v_pk_mul_f32 v[48:49], v[48:49], s[38:39] op_sel_hi:[1,0]
v_pk_mul_f32 v[50:51], v[50:51], s[38:39] op_sel_hi:[1,0]
v_cvt_pk_bf16_f32 v48, v48, v49
v_cvt_pk_bf16_f32 v49, v50, v51
v_pk_mul_f32 v[52:53], v[52:53], s[38:39] op_sel_hi:[1,0]
v_pk_mul_f32 v[54:55], v[54:55], s[38:39] op_sel_hi:[1,0]
v_cvt_pk_bf16_f32 v52, v52, v53
v_cvt_pk_bf16_f32 v53, v54, v55
ds_write_b64 v195, v[48:49] offset:8704
ds_write_b64 v195, v[52:53] offset:9728
s_nop 1
v_pk_mul_f32 v[56:57], v[56:57], s[38:39] op_sel_hi:[1,0]
v_pk_mul_f32 v[58:59], v[58:59], s[38:39] op_sel_hi:[1,0]
v_cvt_pk_bf16_f32 v56, v56, v57
v_cvt_pk_bf16_f32 v57, v58, v59
v_pk_mul_f32 v[60:61], v[60:61], s[38:39] op_sel_hi:[1,0]
v_pk_mul_f32 v[62:63], v[62:63], s[38:39] op_sel_hi:[1,0]
v_cvt_pk_bf16_f32 v60, v60, v61
v_cvt_pk_bf16_f32 v61, v62, v63
ds_write_b64 v195, v[56:57] offset:12800
ds_write_b64 v195, v[60:61] offset:13824
s_waitcnt lgkmcnt(0)
s_barrier
L_att:
ds_read_b128 v[128:131], v216 offset:0
ds_read_b128 v[132:135], v216 offset:1024
ds_read_b128 v[144:147], v216 offset:4096
ds_read_b128 v[148:151], v216 offset:5120
ds_read_b128 v[160:163], v216 offset:8192
ds_read_b128 v[164:167], v216 offset:9216
ds_read_b128 v[224:227], v252 offset:0
ds_read_b128 v[228:231], v252 offset:2048
ds_read_b128 v[232:235], v252 offset:8192
ds_read_b128 v[236:239], v252 offset:10240
s_waitcnt lgkmcnt(3)
v_mfma_f32_16x16x32_bf16 v[192:195], v[224:227], v[128:131], 0
ds_read_b128 v[176:179], v216 offset:12288
v_mfma_f32_16x16x32_bf16 v[200:203], v[224:227], v[132:135], 0
s_waitcnt lgkmcnt(3)
ds_read_b128 v[224:227], v252 offset:16384
v_mfma_f32_16x16x32_bf16 v[196:199], v[228:231], v[128:131], 0
ds_read_b128 v[180:183], v216 offset:13312
v_mfma_f32_16x16x32_bf16 v[204:207], v[228:231], v[132:135], 0
s_waitcnt lgkmcnt(4)
ds_read_b128 v[228:231], v252 offset:18432
v_mfma_f32_16x16x32_bf16 v[192:195], v[232:235], v[144:147], v[192:195]
ds_read_b128 v[136:139], v216 offset:2048
v_mfma_f32_16x16x32_bf16 v[200:203], v[232:235], v[148:151], v[200:203]
s_waitcnt lgkmcnt(5)
ds_read_b128 v[232:235], v252 offset:24576
v_mfma_f32_16x16x32_bf16 v[196:199], v[236:239], v[144:147], v[196:199]
ds_read_b128 v[140:143], v216 offset:3072
v_mfma_f32_16x16x32_bf16 v[204:207], v[236:239], v[148:151], v[204:207]
s_waitcnt lgkmcnt(5)
ds_read_b128 v[236:239], v252 offset:26624
v_xor_b32 v252, 64, v252
v_mfma_f32_16x16x32_bf16 v[192:195], v[224:227], v[160:163], v[192:195]
ds_read_b128 v[152:155], v216 offset:6144
v_mfma_f32_16x16x32_bf16 v[200:203], v[224:227], v[164:167], v[200:203]
s_waitcnt lgkmcnt(5)
ds_read_b128 v[224:227], v252 offset:0
v_mfma_f32_16x16x32_bf16 v[196:199], v[228:231], v[160:163], v[196:199]
ds_read_b128 v[156:159], v216 offset:7168
v_mfma_f32_16x16x32_bf16 v[204:207], v[228:231], v[164:167], v[204:207]
s_waitcnt lgkmcnt(5)
ds_read_b128 v[228:231], v252 offset:2048
v_mfma_f32_16x16x32_bf16 v[192:195], v[232:235], v[176:179], v[192:195]
ds_read_b128 v[168:171], v216 offset:10240
v_mfma_f32_16x16x32_bf16 v[200:203], v[232:235], v[180:183], v[200:203]
s_waitcnt lgkmcnt(5)
ds_read_b128 v[232:235], v252 offset:8192
v_mfma_f32_16x16x32_bf16 v[196:199], v[236:239], v[176:179], v[196:199]
ds_read_b128 v[172:175], v216 offset:11264
v_mfma_f32_16x16x32_bf16 v[204:207], v[236:239], v[180:183], v[204:207]
s_waitcnt lgkmcnt(5)
ds_read_b128 v[236:239], v252 offset:10240
v_mfma_f32_16x16x32_bf16 v[192:195], v[224:227], v[136:139], v[192:195]
ds_read_b128 v[184:187], v216 offset:14336
v_mfma_f32_16x16x32_bf16 v[200:203], v[224:227], v[140:143], v[200:203]
s_waitcnt lgkmcnt(5)
ds_read_b128 v[224:227], v252 offset:16384
v_mfma_f32_16x16x32_bf16 v[196:199], v[228:231], v[136:139], v[196:199]
ds_read_b128 v[188:191], v216 offset:15360
v_mfma_f32_16x16x32_bf16 v[204:207], v[228:231], v[140:143], v[204:207]
s_waitcnt lgkmcnt(5)
ds_read_b128 v[228:231], v252 offset:18432
v_mfma_f32_16x16x32_bf16 v[192:195], v[232:235], v[152:155], v[192:195]
v_mfma_f32_16x16x32_bf16 v[200:203], v[232:235], v[156:159], v[200:203]
s_waitcnt lgkmcnt(4)
ds_read_b128 v[232:235], v252 offset:24576
v_mfma_f32_16x16x32_bf16 v[196:199], v[236:239], v[152:155], v[196:199]
s_waitcnt lgkmcnt(2)
s_barrier
v_mfma_f32_16x16x32_bf16 v[204:207], v[236:239], v[156:159], v[204:207]
ds_read_b128 v[236:239], v252 offset:26624
v_xor_b32 v252, 131072, v252
v_mfma_f32_16x16x32_bf16 v[192:195], v[224:227], v[168:171], v[192:195]
v_mfma_f32_16x16x32_bf16 v[200:203], v[224:227], v[172:175], v[200:203]
s_waitcnt lgkmcnt(2)
ds_read_b128 v[224:227], v252 offset:0
v_mfma_f32_16x16x32_bf16 v[196:199], v[228:231], v[168:171], v[196:199]
v_mfma_f32_16x16x32_bf16 v[204:207], v[228:231], v[172:175], v[204:207]
s_waitcnt lgkmcnt(2)
ds_read_b128 v[228:231], v252 offset:2048
v_mfma_f32_16x16x32_bf16 v[192:195], v[232:235], v[184:187], v[192:195]
v_mfma_f32_16x16x32_bf16 v[200:203], v[232:235], v[188:191], v[200:203]
s_waitcnt lgkmcnt(2)
ds_read_b128 v[232:235], v252 offset:8192
v_mfma_f32_16x16x32_bf16 v[196:199], v[236:239], v[184:187], v[196:199]
v_mfma_f32_16x16x32_bf16 v[204:207], v[236:239], v[188:191], v[204:207]
s_waitcnt lgkmcnt(2)
ds_read_b128 v[236:239], v252 offset:10240
v_mfma_f32_16x16x32_bf16 v[208:211], v[224:227], v[136:139], 0
s_nop 2
v_mfma_f32_16x16x32_bf16 v[216:219], v[224:227], v[140:143], 0
s_waitcnt lgkmcnt(2)
ds_read_b128 v[224:227], v252 offset:16384
v_mfma_f32_16x16x32_bf16 v[212:215], v[228:231], v[136:139], 0
v_max3_f32 v0, v192, v193, v194
v_max3_f32 v0, v0, v195, v196
v_max3_f32 v0, v0, v197, v198
v_max_f32 v0, v0, v199
v_mfma_f32_16x16x32_bf16 v[220:223], v[228:231], v[140:143], 0
s_waitcnt lgkmcnt(2)
ds_read_b128 v[228:231], v252 offset:18432
v_max3_f32 v1, v200, v201, v202
v_max3_f32 v1, v1, v203, v204
v_max3_f32 v1, v1, v205, v206
v_max_f32 v1, v1, v207
v_mfma_f32_16x16x32_bf16 v[208:211], v[232:235], v[152:155], v[208:211]
v_mov_b32 v2, v0
v_mov_b32 v3, v1
s_nop 0
v_permlane32_swap_b32 v0, v2
v_mfma_f32_16x16x32_bf16 v[216:219], v[232:235], v[156:159], v[216:219]
s_waitcnt lgkmcnt(2)
ds_read_b128 v[232:235], v252 offset:24576
v_permlane32_swap_b32 v1, v3
v_max_f32 v0, v0, v2
v_max_f32 v1, v1, v3
v_mov_b32 v2, v0
v_mfma_f32_16x16x32_bf16 v[212:215], v[236:239], v[152:155], v[212:215]
v_mov_b32 v3, v1
s_nop 0
v_permlane16_swap_b32 v0, v2
v_permlane16_swap_b32 v1, v3
v_mfma_f32_16x16x32_bf16 v[220:223], v[236:239], v[156:159], v[220:223]
s_waitcnt lgkmcnt(2)
ds_read_b128 v[236:239], v252 offset:26624
v_xor_b32 v252, 64, v252
v_max_f32 v0, v0, v2
v_max_f32 v1, v1, v3
v_mfma_f32_16x16x32_bf16 v[208:211], v[224:227], v[168:171], v[208:211]
v_sub_f32 v192, v192, v0
v_sub_f32 v193, v193, v0
v_mfma_f32_16x16x32_bf16 v[216:219], v[224:227], v[172:175], v[216:219]
s_waitcnt lgkmcnt(2)
ds_read_b128 v[224:227], v252 offset:0
v_sub_f32 v194, v194, v0
v_mfma_f32_16x16x32_bf16 v[212:215], v[228:231], v[168:171], v[212:215]
v_exp_f32 v192, v192
v_mfma_f32_16x16x32_bf16 v[220:223], v[228:231], v[172:175], v[220:223]
s_waitcnt lgkmcnt(2)
ds_read_b128 v[228:231], v252 offset:2048
v_sub_f32 v195, v195, v0
v_mfma_f32_16x16x32_bf16 v[208:211], v[232:235], v[184:187], v[208:211]
v_exp_f32 v193, v193
v_sub_f32 v196, v196, v0
v_mfma_f32_16x16x32_bf16 v[216:219], v[232:235], v[188:191], v[216:219]
s_waitcnt lgkmcnt(2)
ds_read_b128 v[232:235], v252 offset:8192
v_sub_f32 v197, v197, v0
v_mfma_f32_16x16x32_bf16 v[212:215], v[236:239], v[184:187], v[212:215]
v_exp_f32 v194, v194
v_sub_f32 v198, v198, v0
v_mfma_f32_16x16x32_bf16 v[220:223], v[236:239], v[188:191], v[220:223]
s_waitcnt lgkmcnt(2)
ds_read_b128 v[236:239], v252 offset:10240
v_sub_f32 v199, v199, v0
v_mfma_f32_16x16x32_bf16 v[208:211], v[224:227], v[128:131], v[208:211]
v_exp_f32 v195, v195
v_sub_f32 v200, v200, v1
v_mfma_f32_16x16x32_bf16 v[216:219], v[224:227], v[132:135], v[216:219]
s_waitcnt lgkmcnt(2)
ds_read_b128 v[224:227], v252 offset:16384
v_sub_f32 v201, v201, v1
v_exp_f32 v196, v196
v_mfma_f32_16x16x32_bf16 v[212:215], v[228:231], v[128:131], v[212:215]
v_exp_f32 v197, v197
v_sub_f32 v202, v202, v1
v_mfma_f32_16x16x32_bf16 v[220:223], v[228:231], v[132:135], v[220:223]
s_waitcnt lgkmcnt(2)
ds_read_b128 v[228:231], v252 offset:18432
v_sub_f32 v203, v203, v1
v_exp_f32 v198, v198
v_mfma_f32_16x16x32_bf16 v[208:211], v[232:235], v[144:147], v[208:211]
v_exp_f32 v199, v199
v_sub_f32 v204, v204, v1
v_mfma_f32_16x16x32_bf16 v[216:219], v[232:235], v[148:151], v[216:219]
s_waitcnt lgkmcnt(2)
ds_read_b128 v[232:235], v252 offset:24576
v_sub_f32 v205, v205, v1
v_exp_f32 v200, v200
v_mov_b32 v254, v192
v_mfma_f32_16x16x32_bf16 v[212:215], v[236:239], v[144:147], v[212:215]
s_barrier
v_exp_f32 v201, v201
v_sub_f32 v206, v206, v1
v_add_f32 v254, v254, v193
v_mfma_f32_16x16x32_bf16 v[220:223], v[236:239], v[148:151], v[220:223]
s_waitcnt lgkmcnt(2)
ds_read_b128 v[236:239], v252 offset:26624
v_xor_b32 v253, 32832, v253
v_cvt_pk_bf16_f32 v192, v192, v193
v_sub_f32 v207, v207, v1
v_exp_f32 v202, v202
v_add_f32 v254, v254, v194
v_mfma_f32_16x16x32_bf16 v[208:211], v[224:227], v[160:163], v[208:211]
v_exp_f32 v203, v203
v_cvt_pk_bf16_f32 v193, v194, v195
v_add_f32 v254, v254, v195
v_mfma_f32_16x16x32_bf16 v[216:219], v[224:227], v[164:167], v[216:219]
s_waitcnt lgkmcnt(2)
ds_read_b64_tr_b16 v[224:225], v253 offset:0
v_cvt_pk_bf16_f32 v194, v196, v197
v_exp_f32 v204, v204
v_add_f32 v254, v254, v196
v_mfma_f32_16x16x32_bf16 v[212:215], v[228:231], v[160:163], v[212:215]
ds_read_b64_tr_b16 v[226:227], v253 offset:2048
v_cvt_pk_bf16_f32 v195, v198, v199
v_exp_f32 v205, v205
v_add_f32 v254, v254, v197
v_mfma_f32_16x16x32_bf16 v[220:223], v[228:231], v[164:167], v[220:223]
s_waitcnt lgkmcnt(3)
ds_read_b64_tr_b16 v[228:229], v253 offset:8192
v_cvt_pk_bf16_f32 v196, v200, v201
v_exp_f32 v206, v206
v_add_f32 v254, v254, v198
v_mfma_f32_16x16x32_bf16 v[208:211], v[232:235], v[176:179], v[208:211]
ds_read_b64_tr_b16 v[230:231], v253 offset:10240
v_cvt_pk_bf16_f32 v197, v202, v203
v_sub_f32 v244, 0, v0
v_sub_f32 v245, 0, v0
v_sub_f32 v246, 0, v0
v_sub_f32 v247, 0, v0
v_sub_f32 v248, 0, v1
v_sub_f32 v249, 0, v1
v_sub_f32 v250, 0, v1
v_sub_f32 v251, 0, v1
v_exp_f32 v207, v207
v_add_f32 v254, v254, v199
v_mfma_f32_16x16x32_bf16 v[216:219], v[232:235], v[180:183], v[216:219]
s_waitcnt lgkmcnt(4)
ds_read_b64_tr_b16 v[232:233], v253 offset:16384
v_cvt_pk_bf16_f32 v198, v204, v205
v_mov_b32 v255, v200
v_add_f32 v255, v255, v201
v_mfma_f32_16x16x32_bf16 v[212:215], v[236:239], v[176:179], v[212:215]
ds_read_b64_tr_b16 v[234:235], v253 offset:18432
v_cvt_pk_bf16_f32 v199, v206, v207
v_mfma_f32_16x16x32_bf16 v[220:223], v[236:239], v[180:183], v[220:223]
s_waitcnt lgkmcnt(4)
ds_read_b64_tr_b16 v[236:237], v253 offset:24576
v_add_f32 v255, v255, v202
v_mfma_f32_16x16x32_bf16 v[64:67], v[224:227], v[192:195], 0
ds_read_b64_tr_b16 v[238:239], v253 offset:26624
v_xor_b32 v253, 32, v253
v_mfma_f32_16x16x32_bf16 v[72:75], v[224:227], v[196:199], 0
s_waitcnt lgkmcnt(4)
ds_read_b64_tr_b16 v[224:225], v253 offset:0
v_add_f32 v255, v255, v203
v_mfma_f32_16x16x32_bf16 v[80:83], v[228:231], v[192:195], 0
ds_read_b64_tr_b16 v[226:227], v253 offset:2048
v_add_f32 v255, v255, v204
v_mfma_f32_16x16x32_bf16 v[88:91], v[228:231], v[196:199], 0
s_waitcnt lgkmcnt(4)
ds_read_b64_tr_b16 v[228:229], v253 offset:8192
v_add_f32 v255, v255, v205
v_mfma_f32_16x16x32_bf16 v[96:99], v[232:235], v[192:195], 0
ds_read_b64_tr_b16 v[230:231], v253 offset:10240
v_add_f32 v255, v255, v206
v_mfma_f32_16x16x32_bf16 v[104:107], v[232:235], v[196:199], 0
s_waitcnt lgkmcnt(4)
ds_read_b64_tr_b16 v[232:233], v253 offset:16384
v_add_f32 v255, v255, v207
v_mfma_f32_16x16x32_bf16 v[112:115], v[236:239], v[192:195], 0
ds_read_b64_tr_b16 v[234:235], v253 offset:18432
v_add_f32 v208, v208, v244
v_mfma_f32_16x16x32_bf16 v[120:123], v[236:239], v[196:199], 0
s_waitcnt lgkmcnt(4)
ds_read_b64_tr_b16 v[236:237], v253 offset:24576
v_add_f32 v209, v209, v244
v_mfma_f32_16x16x32_bf16 v[68:71], v[224:227], v[192:195], 0
ds_read_b64_tr_b16 v[238:239], v253 offset:26624
v_xor_b32 v253, 64, v253
v_mfma_f32_16x16x32_bf16 v[76:79], v[224:227], v[196:199], 0
s_waitcnt lgkmcnt(4)
ds_read_b64_tr_b16 v[224:225], v253 offset:0
v_add_f32 v210, v210, v244
v_mfma_f32_16x16x32_bf16 v[84:87], v[228:231], v[192:195], 0
ds_read_b64_tr_b16 v[226:227], v253 offset:2048
v_add_f32 v211, v211, v244
v_mfma_f32_16x16x32_bf16 v[92:95], v[228:231], v[196:199], 0
s_waitcnt lgkmcnt(4)
ds_read_b64_tr_b16 v[228:229], v253 offset:8192
v_add_f32 v212, v212, v244
v_mfma_f32_16x16x32_bf16 v[100:103], v[232:235], v[192:195], 0
ds_read_b64_tr_b16 v[230:231], v253 offset:10240
v_add_f32 v213, v213, v244
v_mfma_f32_16x16x32_bf16 v[108:111], v[232:235], v[196:199], 0
s_waitcnt lgkmcnt(4)
ds_read_b64_tr_b16 v[232:233], v253 offset:16384
v_add_f32 v214, v214, v244
v_add_f32 v215, v215, v244
v_mfma_f32_16x16x32_bf16 v[116:119], v[236:239], v[192:195], 0
ds_read_b64_tr_b16 v[234:235], v253 offset:18432
v_add_f32 v216, v216, v248
v_add_f32 v217, v217, v248
v_mfma_f32_16x16x32_bf16 v[124:127], v[236:239], v[196:199], 0
s_waitcnt lgkmcnt(4)
ds_read_b64_tr_b16 v[236:237], v253 offset:24576
v_add_f32 v218, v218, v248
v_mfma_f32_16x16x32_bf16 v[4:7], v[224:227], v[192:195], 0
ds_read_b64_tr_b16 v[238:239], v253 offset:26624
v_xor_b32 v253, 32, v253
v_add_f32 v219, v219, v248
v_add_f32 v220, v220, v248
v_mfma_f32_16x16x32_bf16 v[12:15], v[224:227], v[196:199], 0
s_waitcnt lgkmcnt(4)
ds_read_b64_tr_b16 v[224:225], v253 offset:0
v_add_f32 v221, v221, v248
v_add_f32 v222, v222, v248
v_mfma_f32_16x16x32_bf16 v[20:23], v[228:231], v[192:195], 0
ds_read_b64_tr_b16 v[226:227], v253 offset:2048
v_add_f32 v223, v223, v248
v_mfma_f32_16x16x32_bf16 v[28:31], v[228:231], v[196:199], 0
s_waitcnt lgkmcnt(4)
ds_read_b64_tr_b16 v[228:229], v253 offset:8192
v_max3_f32 v200, v208, v209, v210
v_max3_f32 v200, v200, v211, v212
v_mfma_f32_16x16x32_bf16 v[36:39], v[232:235], v[192:195], 0
ds_read_b64_tr_b16 v[230:231], v253 offset:10240
v_max3_f32 v200, v200, v213, v214
v_max3_f32 v200, v200, v215, v216
v_mfma_f32_16x16x32_bf16 v[44:47], v[232:235], v[196:199], 0
s_waitcnt lgkmcnt(4)
ds_read_b64_tr_b16 v[232:233], v253 offset:16384
v_max3_f32 v200, v200, v217, v218
v_mfma_f32_16x16x32_bf16 v[52:55], v[236:239], v[192:195], 0
s_barrier
ds_read_b64_tr_b16 v[234:235], v253 offset:18432
v_max3_f32 v200, v200, v219, v220
v_max3_f32 v200, v200, v221, v222
v_mfma_f32_16x16x32_bf16 v[60:63], v[236:239], v[196:199], 0
s_waitcnt lgkmcnt(4)
ds_read_b64_tr_b16 v[236:237], v253 offset:24576
v_max_f32 v200, v200, v223
v_cmp_lt_f32 vcc, s39, v200
v_mfma_f32_16x16x32_bf16 v[0:3], v[224:227], v[192:195], 0
s_cbranch_vccnz L_stub1
L_back1:
ds_read_b64_tr_b16 v[238:239], v253 offset:26624
v_xor_b32 v252, 65536, v252
v_mfma_f32_16x16x32_bf16 v[8:11], v[224:227], v[196:199], 0
s_waitcnt lgkmcnt(4)
ds_read_b128 v[224:227], v252 offset:0
v_mfma_f32_16x16x32_bf16 v[16:19], v[228:231], v[192:195], 0
s_cmp_eq_u32 s86, 0
v_exp_f32 v208, v208
v_mfma_f32_16x16x32_bf16 v[24:27], v[228:231], v[196:199], 0
s_waitcnt lgkmcnt(3)
ds_read_b128 v[228:231], v252 offset:2048
v_add_f32 v254, v254, v208
v_mfma_f32_16x16x32_bf16 v[32:35], v[232:235], v[192:195], 0
s_cbranch_scc1 L_mk0
L_mkb0:
v_exp_f32 v209, v209
v_mfma_f32_16x16x32_bf16 v[40:43], v[232:235], v[196:199], 0
s_waitcnt lgkmcnt(2)
ds_read_b128 v[232:235], v252 offset:8192
v_add_f32 v254, v254, v209
v_mfma_f32_16x16x32_bf16 v[48:51], v[236:239], v[192:195], 0
v_exp_f32 v210, v210
v_mfma_f32_16x16x32_bf16 v[56:59], v[236:239], v[196:199], 0
s_waitcnt lgkmcnt(2)
ds_read_b128 v[236:239], v252 offset:10240
v_cvt_pk_bf16_f32 v208, v208, v209
v_mfma_f32_16x16x32_bf16 v[192:195], v[224:227], v[128:131], v[244:247]
v_exp_f32 v211, v211
v_mfma_f32_16x16x32_bf16 v[200:203], v[224:227], v[132:135], v[248:251]
s_waitcnt lgkmcnt(2)
ds_read_b128 v[224:227], v252 offset:16384
v_add_f32 v254, v254, v210
v_mfma_f32_16x16x32_bf16 v[196:199], v[228:231], v[128:131], v[244:247]
v_exp_f32 v212, v212
v_mfma_f32_16x16x32_bf16 v[204:207], v[228:231], v[132:135], v[248:251]
s_waitcnt lgkmcnt(2)
ds_read_b128 v[228:231], v252 offset:18432
v_cvt_pk_bf16_f32 v209, v210, v211
v_mfma_f32_16x16x32_bf16 v[192:195], v[232:235], v[144:147], v[192:195]
v_exp_f32 v213, v213
v_mfma_f32_16x16x32_bf16 v[200:203], v[232:235], v[148:151], v[200:203]
s_waitcnt lgkmcnt(2)
ds_read_b128 v[232:235], v252 offset:24576
v_add_f32 v254, v254, v211
v_mfma_f32_16x16x32_bf16 v[196:199], v[236:239], v[144:147], v[196:199]
v_exp_f32 v214, v214
v_mfma_f32_16x16x32_bf16 v[204:207], v[236:239], v[148:151], v[204:207]
s_waitcnt lgkmcnt(2)
ds_read_b128 v[236:239], v252 offset:26624
v_xor_b32 v252, 64, v252
v_mfma_f32_16x16x32_bf16 v[192:195], v[224:227], v[160:163], v[192:195]
v_exp_f32 v215, v215
v_mfma_f32_16x16x32_bf16 v[200:203], v[224:227], v[164:167], v[200:203]
s_waitcnt lgkmcnt(2)
ds_read_b128 v[224:227], v252 offset:0
v_cvt_pk_bf16_f32 v210, v212, v213
v_mfma_f32_16x16x32_bf16 v[196:199], v[228:231], v[160:163], v[196:199]
v_exp_f32 v216, v216
v_mfma_f32_16x16x32_bf16 v[204:207], v[228:231], v[164:167], v[204:207]
s_waitcnt lgkmcnt(2)
ds_read_b128 v[228:231], v252 offset:2048
v_add_f32 v254, v254, v212
v_mfma_f32_16x16x32_bf16 v[192:195], v[232:235], v[176:179], v[192:195]
v_exp_f32 v217, v217
v_mfma_f32_16x16x32_bf16 v[200:203], v[232:235], v[180:183], v[200:203]
s_waitcnt lgkmcnt(2)
ds_read_b128 v[232:235], v252 offset:8192
v_cvt_pk_bf16_f32 v211, v214, v215
v_mfma_f32_16x16x32_bf16 v[196:199], v[236:239], v[176:179], v[196:199]
v_exp_f32 v218, v218
v_mfma_f32_16x16x32_bf16 v[204:207], v[236:239], v[180:183], v[204:207]
s_waitcnt lgkmcnt(2)
ds_read_b128 v[236:239], v252 offset:10240
v_add_f32 v254, v254, v213
v_mfma_f32_16x16x32_bf16 v[192:195], v[224:227], v[136:139], v[192:195]
v_exp_f32 v219, v219
v_mfma_f32_16x16x32_bf16 v[200:203], v[224:227], v[140:143], v[200:203]
s_waitcnt lgkmcnt(2)
ds_read_b128 v[224:227], v252 offset:16384
v_cvt_pk_bf16_f32 v212, v216, v217
v_mfma_f32_16x16x32_bf16 v[196:199], v[228:231], v[136:139], v[196:199]
v_exp_f32 v220, v220
v_mfma_f32_16x16x32_bf16 v[204:207], v[228:231], v[140:143], v[204:207]
s_waitcnt lgkmcnt(2)
ds_read_b128 v[228:231], v252 offset:18432
v_add_f32 v254, v254, v214
v_mfma_f32_16x16x32_bf16 v[192:195], v[232:235], v[152:155], v[192:195]
v_exp_f32 v221, v221
v_mfma_f32_16x16x32_bf16 v[200:203], v[232:235], v[156:159], v[200:203]
s_waitcnt lgkmcnt(2)
ds_read_b128 v[232:235], v252 offset:24576
v_cvt_pk_bf16_f32 v213, v218, v219
v_mfma_f32_16x16x32_bf16 v[196:199], v[236:239], v[152:155], v[196:199]
s_barrier
v_exp_f32 v222, v222
v_mfma_f32_16x16x32_bf16 v[204:207], v[236:239], v[156:159], v[204:207]
s_waitcnt lgkmcnt(2)
ds_read_b128 v[236:239], v252 offset:26624
v_xor_b32 v253, 65600, v253
v_mfma_f32_16x16x32_bf16 v[192:195], v[224:227], v[168:171], v[192:195]
v_exp_f32 v223, v223
v_mfma_f32_16x16x32_bf16 v[200:203], v[224:227], v[172:175], v[200:203]
s_waitcnt lgkmcnt(2)
ds_read_b64_tr_b16 v[224:225], v253 offset:0
v_add_f32 v254, v254, v215
v_mfma_f32_16x16x32_bf16 v[196:199], v[228:231], v[168:171], v[196:199]
ds_read_b64_tr_b16 v[226:227], v253 offset:2048
v_cvt_pk_bf16_f32 v214, v220, v221
v_mfma_f32_16x16x32_bf16 v[204:207], v[228:231], v[172:175], v[204:207]
s_waitcnt lgkmcnt(3)
ds_read_b64_tr_b16 v[228:229], v253 offset:8192
v_add_f32 v255, v255, v216
v_mfma_f32_16x16x32_bf16 v[192:195], v[232:235], v[184:187], v[192:195]
ds_read_b64_tr_b16 v[230:231], v253 offset:10240
v_add_f32 v255, v255, v217
v_mfma_f32_16x16x32_bf16 v[200:203], v[232:235], v[188:191], v[200:203]
s_waitcnt lgkmcnt(4)
ds_read_b64_tr_b16 v[232:233], v253 offset:16384
v_cvt_pk_bf16_f32 v215, v222, v223
v_mfma_f32_16x16x32_bf16 v[196:199], v[236:239], v[184:187], v[196:199]
ds_read_b64_tr_b16 v[234:235], v253 offset:18432
v_add_f32 v255, v255, v218
v_mfma_f32_16x16x32_bf16 v[204:207], v[236:239], v[188:191], v[204:207]
s_waitcnt lgkmcnt(4)
ds_read_b64_tr_b16 v[236:237], v253 offset:24576
v_add_f32 v255, v255, v219
v_mfma_f32_16x16x32_bf16 v[64:67], v[224:227], v[208:211], v[64:67]
ds_read_b64_tr_b16 v[238:239], v253 offset:26624
v_xor_b32 v253, 32, v253
v_mfma_f32_16x16x32_bf16 v[72:75], v[224:227], v[212:215], v[72:75]
s_waitcnt lgkmcnt(4)
ds_read_b64_tr_b16 v[224:225], v253 offset:0
v_add_f32 v255, v255, v220
v_mfma_f32_16x16x32_bf16 v[80:83], v[228:231], v[208:211], v[80:83]
ds_read_b64_tr_b16 v[226:227], v253 offset:2048
v_add_f32 v255, v255, v221
v_mfma_f32_16x16x32_bf16 v[88:91], v[228:231], v[212:215], v[88:91]
s_waitcnt lgkmcnt(4)
ds_read_b64_tr_b16 v[228:229], v253 offset:8192
v_add_f32 v255, v255, v222
v_mfma_f32_16x16x32_bf16 v[96:99], v[232:235], v[208:211], v[96:99]
ds_read_b64_tr_b16 v[230:231], v253 offset:10240
v_add_f32 v255, v255, v223
v_mfma_f32_16x16x32_bf16 v[104:107], v[232:235], v[212:215], v[104:107]
s_waitcnt lgkmcnt(4)
ds_read_b64_tr_b16 v[232:233], v253 offset:16384
v_max3_f32 v216, v192, v193, v194
v_mfma_f32_16x16x32_bf16 v[112:115], v[236:239], v[208:211], v[112:115]
ds_read_b64_tr_b16 v[234:235], v253 offset:18432
v_max3_f32 v216, v216, v195, v196
v_mfma_f32_16x16x32_bf16 v[120:123], v[236:239], v[212:215], v[120:123]
s_waitcnt lgkmcnt(4)
ds_read_b64_tr_b16 v[236:237], v253 offset:24576
v_max3_f32 v216, v216, v197, v198
v_mfma_f32_16x16x32_bf16 v[68:71], v[224:227], v[208:211], v[68:71]
ds_read_b64_tr_b16 v[238:239], v253 offset:26624
v_xor_b32 v253, 64, v253
v_mfma_f32_16x16x32_bf16 v[76:79], v[224:227], v[212:215], v[76:79]
s_waitcnt lgkmcnt(4)
ds_read_b64_tr_b16 v[224:225], v253 offset:0
v_max3_f32 v216, v216, v199, v200
v_mfma_f32_16x16x32_bf16 v[84:87], v[228:231], v[208:211], v[84:87]
ds_read_b64_tr_b16 v[226:227], v253 offset:2048
v_max3_f32 v216, v216, v201, v202
v_mfma_f32_16x16x32_bf16 v[92:95], v[228:231], v[212:215], v[92:95]
s_waitcnt lgkmcnt(4)
ds_read_b64_tr_b16 v[228:229], v253 offset:8192
v_max3_f32 v216, v216, v203, v204
v_mfma_f32_16x16x32_bf16 v[100:103], v[232:235], v[208:211], v[100:103]
ds_read_b64_tr_b16 v[230:231], v253 offset:10240
v_max3_f32 v216, v216, v205, v206
v_mfma_f32_16x16x32_bf16 v[108:111], v[232:235], v[212:215], v[108:111]
s_waitcnt lgkmcnt(4)
ds_read_b64_tr_b16 v[232:233], v253 offset:16384
v_max_f32 v216, v216, v207
v_mfma_f32_16x16x32_bf16 v[116:119], v[236:239], v[208:211], v[116:119]
ds_read_b64_tr_b16 v[234:235], v253 offset:18432
v_cmp_lt_f32 vcc, s39, v216
v_mfma_f32_16x16x32_bf16 v[124:127], v[236:239], v[212:215], v[124:127]
s_waitcnt lgkmcnt(4)
ds_read_b64_tr_b16 v[236:237], v253 offset:24576
v_mfma_f32_16x16x32_bf16 v[4:7], v[224:227], v[208:211], v[4:7]
ds_read_b64_tr_b16 v[238:239], v253 offset:26624
v_xor_b32 v253, 32, v253
v_mfma_f32_16x16x32_bf16 v[12:15], v[224:227], v[212:215], v[12:15]
s_waitcnt lgkmcnt(4)
ds_read_b64_tr_b16 v[224:225], v253 offset:0
v_mfma_f32_16x16x32_bf16 v[20:23], v[228:231], v[208:211], v[20:23]
ds_read_b64_tr_b16 v[226:227], v253 offset:2048
v_mfma_f32_16x16x32_bf16 v[28:31], v[228:231], v[212:215], v[28:31]
s_waitcnt lgkmcnt(4)
ds_read_b64_tr_b16 v[228:229], v253 offset:8192
v_mfma_f32_16x16x32_bf16 v[36:39], v[232:235], v[208:211], v[36:39]
ds_read_b64_tr_b16 v[230:231], v253 offset:10240
v_mfma_f32_16x16x32_bf16 v[44:47], v[232:235], v[212:215], v[44:47]
s_waitcnt lgkmcnt(4)
ds_read_b64_tr_b16 v[232:233], v253 offset:16384
v_mfma_f32_16x16x32_bf16 v[52:55], v[236:239], v[208:211], v[52:55]
s_barrier
ds_read_b64_tr_b16 v[234:235], v253 offset:18432
v_mfma_f32_16x16x32_bf16 v[60:63], v[236:239], v[212:215], v[60:63]
s_waitcnt lgkmcnt(4)
ds_read_b64_tr_b16 v[236:237], v253 offset:24576
v_mfma_f32_16x16x32_bf16 v[0:3], v[224:227], v[208:211], v[0:3]
s_cbranch_vccnz L_stub2
L_back2:
ds_read_b64_tr_b16 v[238:239], v253 offset:26624
v_xor_b32 v252, 65536, v252
v_mfma_f32_16x16x32_bf16 v[8:11], v[224:227], v[212:215], v[8:11]
s_waitcnt lgkmcnt(4)
ds_read_b128 v[224:227], v252 offset:0
v_mfma_f32_16x16x32_bf16 v[16:19], v[228:231], v[208:211], v[16:19]
s_cmp_eq_u32 s86, 1
v_exp_f32 v192, v192
v_mfma_f32_16x16x32_bf16 v[24:27], v[228:231], v[212:215], v[24:27]
s_waitcnt lgkmcnt(3)
ds_read_b128 v[228:231], v252 offset:2048
v_add_f32 v254, v254, v192
v_mfma_f32_16x16x32_bf16 v[32:35], v[232:235], v[208:211], v[32:35]
s_cbranch_scc1 L_mk1
L_mkb1:
v_exp_f32 v193, v193
v_mfma_f32_16x16x32_bf16 v[40:43], v[232:235], v[212:215], v[40:43]
s_waitcnt lgkmcnt(2)
ds_read_b128 v[232:235], v252 offset:8192
v_add_f32 v254, v254, v193
v_mfma_f32_16x16x32_bf16 v[48:51], v[236:239], v[208:211], v[48:51]
v_exp_f32 v194, v194
v_mfma_f32_16x16x32_bf16 v[56:59], v[236:239], v[212:215], v[56:59]
s_waitcnt lgkmcnt(2)
ds_read_b128 v[236:239], v252 offset:10240
v_cvt_pk_bf16_f32 v192, v192, v193
v_mfma_f32_16x16x32_bf16 v[208:211], v[224:227], v[136:139], v[244:247]
L_loop:
v_exp_f32 v195, v195
v_mfma_f32_16x16x32_bf16 v[216:219], v[224:227], v[140:143], v[248:251]
s_waitcnt lgkmcnt(2)
ds_read_b128 v[224:227], v252 offset:16384
v_add_f32 v254, v254, v194
v_mfma_f32_16x16x32_bf16 v[212:215], v[228:231], v[136:139], v[244:247]
v_exp_f32 v196, v196
v_mfma_f32_16x16x32_bf16 v[220:223], v[228:231], v[140:143], v[248:251]
s_waitcnt lgkmcnt(2)
ds_read_b128 v[228:231], v252 offset:18432
v_cvt_pk_bf16_f32 v193, v194, v195
v_mfma_f32_16x16x32_bf16 v[208:211], v[232:235], v[152:155], v[208:211]
v_exp_f32 v197, v197
v_mfma_f32_16x16x32_bf16 v[216:219], v[232:235], v[156:159], v[216:219]
s_waitcnt lgkmcnt(2)
ds_read_b128 v[232:235], v252 offset:24576
v_add_f32 v254, v254, v195
v_mfma_f32_16x16x32_bf16 v[212:215], v[236:239], v[152:155], v[212:215]
v_exp_f32 v198, v198
v_mfma_f32_16x16x32_bf16 v[220:223], v[236:239], v[156:159], v[220:223]
s_waitcnt lgkmcnt(2)
ds_read_b128 v[236:239], v252 offset:26624
v_xor_b32 v252, 64, v252
v_mfma_f32_16x16x32_bf16 v[208:211], v[224:227], v[168:171], v[208:211]
v_exp_f32 v199, v199
v_mfma_f32_16x16x32_bf16 v[216:219], v[224:227], v[172:175], v[216:219]
s_waitcnt lgkmcnt(2)
ds_read_b128 v[224:227], v252 offset:0
v_cvt_pk_bf16_f32 v194, v196, v197
v_mfma_f32_16x16x32_bf16 v[212:215], v[228:231], v[168:171], v[212:215]
v_exp_f32 v200, v200
v_mfma_f32_16x16x32_bf16 v[220:223], v[228:231], v[172:175], v[220:223]
s_waitcnt lgkmcnt(2)
ds_read_b128 v[228:231], v252 offset:2048
v_add_f32 v254, v254, v196
v_mfma_f32_16x16x32_bf16 v[208:211], v[232:235], v[184:187], v[208:211]
v_exp_f32 v201, v201
v_mfma_f32_16x16x32_bf16 v[216:219], v[232:235], v[188:191], v[216:219]
s_waitcnt lgkmcnt(2)
ds_read_b128 v[232:235], v252 offset:8192
v_cvt_pk_bf16_f32 v195, v198, v199
v_mfma_f32_16x16x32_bf16 v[212:215], v[236:239], v[184:187], v[212:215]
v_exp_f32 v202, v202
v_mfma_f32_16x16x32_bf16 v[220:223], v[236:239], v[188:191], v[220:223]
s_waitcnt lgkmcnt(2)
ds_read_b128 v[236:239], v252 offset:10240
v_add_f32 v254, v254, v197
v_mfma_f32_16x16x32_bf16 v[208:211], v[224:227], v[128:131], v[208:211]
v_exp_f32 v203, v203
v_mfma_f32_16x16x32_bf16 v[216:219], v[224:227], v[132:135], v[216:219]
s_waitcnt lgkmcnt(2)
ds_read_b128 v[224:227], v252 offset:16384
v_cvt_pk_bf16_f32 v196, v200, v201
v_mfma_f32_16x16x32_bf16 v[212:215], v[228:231], v[128:131], v[212:215]
v_exp_f32 v204, v204
v_mfma_f32_16x16x32_bf16 v[220:223], v[228:231], v[132:135], v[220:223]
s_waitcnt lgkmcnt(2)
ds_read_b128 v[228:231], v252 offset:18432
v_add_f32 v254, v254, v198
v_mfma_f32_16x16x32_bf16 v[208:211], v[232:235], v[144:147], v[208:211]
v_exp_f32 v205, v205
v_mfma_f32_16x16x32_bf16 v[216:219], v[232:235], v[148:151], v[216:219]
s_waitcnt lgkmcnt(2)
ds_read_b128 v[232:235], v252 offset:24576
v_cvt_pk_bf16_f32 v197, v202, v203
v_mfma_f32_16x16x32_bf16 v[212:215], v[236:239], v[144:147], v[212:215]
s_barrier
v_exp_f32 v206, v206
v_mfma_f32_16x16x32_bf16 v[220:223], v[236:239], v[148:151], v[220:223]
s_waitcnt lgkmcnt(2)
ds_read_b128 v[236:239], v252 offset:26624
v_xor_b32 v253, s40, v253
v_mfma_f32_16x16x32_bf16 v[208:211], v[224:227], v[160:163], v[208:211]
v_exp_f32 v207, v207
v_mfma_f32_16x16x32_bf16 v[216:219], v[224:227], v[164:167], v[216:219]
s_waitcnt lgkmcnt(2)
ds_read_b64_tr_b16 v[224:225], v253 offset:0
v_add_f32 v254, v254, v199
v_mfma_f32_16x16x32_bf16 v[212:215], v[228:231], v[160:163], v[212:215]
ds_read_b64_tr_b16 v[226:227], v253 offset:2048
v_cvt_pk_bf16_f32 v198, v204, v205
v_mfma_f32_16x16x32_bf16 v[220:223], v[228:231], v[164:167], v[220:223]
s_waitcnt lgkmcnt(3)
ds_read_b64_tr_b16 v[228:229], v253 offset:8192
v_add_f32 v255, v255, v200
v_mfma_f32_16x16x32_bf16 v[208:211], v[232:235], v[176:179], v[208:211]
ds_read_b64_tr_b16 v[230:231], v253 offset:10240
v_add_f32 v255, v255, v201
v_mfma_f32_16x16x32_bf16 v[216:219], v[232:235], v[180:183], v[216:219]
s_waitcnt lgkmcnt(4)
ds_read_b64_tr_b16 v[232:233], v253 offset:16384
v_cvt_pk_bf16_f32 v199, v206, v207
v_mfma_f32_16x16x32_bf16 v[212:215], v[236:239], v[176:179], v[212:215]
ds_read_b64_tr_b16 v[234:235], v253 offset:18432
v_add_f32 v255, v255, v202
v_mfma_f32_16x16x32_bf16 v[220:223], v[236:239], v[180:183], v[220:223]
s_waitcnt lgkmcnt(4)
ds_read_b64_tr_b16 v[236:237], v253 offset:24576
v_add_f32 v255, v255, v203
v_mfma_f32_16x16x32_bf16 v[64:67], v[224:227], v[192:195], v[64:67]
ds_read_b64_tr_b16 v[238:239], v253 offset:26624
v_xor_b32 v253, 32, v253
v_mfma_f32_16x16x32_bf16 v[72:75], v[224:227], v[196:199], v[72:75]
s_waitcnt lgkmcnt(4)
ds_read_b64_tr_b16 v[224:225], v253 offset:0
v_add_f32 v255, v255, v204
v_mfma_f32_16x16x32_bf16 v[80:83], v[228:231], v[192:195], v[80:83]
s_xor_b32 s40, s40, s41
ds_read_b64_tr_b16 v[226:227], v253 offset:2048
v_add_f32 v255, v255, v205
v_mfma_f32_16x16x32_bf16 v[88:91], v[228:231], v[196:199], v[88:91]
s_waitcnt lgkmcnt(4)
ds_read_b64_tr_b16 v[228:229], v253 offset:8192
v_add_f32 v255, v255, v206
v_mfma_f32_16x16x32_bf16 v[96:99], v[232:235], v[192:195], v[96:99]
s_xor_b32 s40, 64, s40
ds_read_b64_tr_b16 v[230:231], v253 offset:10240
v_add_f32 v255, v255, v207
v_mfma_f32_16x16x32_bf16 v[104:107], v[232:235], v[196:199], v[104:107]
s_waitcnt lgkmcnt(4)
ds_read_b64_tr_b16 v[232:233], v253 offset:16384
v_max3_f32 v200, v208, v209, v210
v_mfma_f32_16x16x32_bf16 v[112:115], v[236:239], v[192:195], v[112:115]
ds_read_b64_tr_b16 v[234:235], v253 offset:18432
v_max3_f32 v200, v200, v211, v212
v_mfma_f32_16x16x32_bf16 v[120:123], v[236:239], v[196:199], v[120:123]
s_waitcnt lgkmcnt(4)
ds_read_b64_tr_b16 v[236:237], v253 offset:24576
v_max3_f32 v200, v200, v213, v214
v_mfma_f32_16x16x32_bf16 v[68:71], v[224:227], v[192:195], v[68:71]
ds_read_b64_tr_b16 v[238:239], v253 offset:26624
v_xor_b32 v253, 64, v253
v_mfma_f32_16x16x32_bf16 v[76:79], v[224:227], v[196:199], v[76:79]
s_waitcnt lgkmcnt(4)
ds_read_b64_tr_b16 v[224:225], v253 offset:0
v_max3_f32 v200, v200, v215, v216
v_mfma_f32_16x16x32_bf16 v[84:87], v[228:231], v[192:195], v[84:87]
ds_read_b64_tr_b16 v[226:227], v253 offset:2048
v_max3_f32 v200, v200, v217, v218
v_mfma_f32_16x16x32_bf16 v[92:95], v[228:231], v[196:199], v[92:95]
s_waitcnt lgkmcnt(4)
ds_read_b64_tr_b16 v[228:229], v253 offset:8192
v_max3_f32 v200, v200, v219, v220
v_mfma_f32_16x16x32_bf16 v[100:103], v[232:235], v[192:195], v[100:103]
ds_read_b64_tr_b16 v[230:231], v253 offset:10240
v_max3_f32 v200, v200, v221, v222
v_mfma_f32_16x16x32_bf16 v[108:111], v[232:235], v[196:199], v[108:111]
s_waitcnt lgkmcnt(4)
ds_read_b64_tr_b16 v[232:233], v253 offset:16384
v_max_f32 v200, v200, v223
v_mfma_f32_16x16x32_bf16 v[116:119], v[236:239], v[192:195], v[116:119]
ds_read_b64_tr_b16 v[234:235], v253 offset:18432
v_cmp_lt_f32 vcc, s39, v200
v_mfma_f32_16x16x32_bf16 v[124:127], v[236:239], v[196:199], v[124:127]
s_waitcnt lgkmcnt(4)
ds_read_b64_tr_b16 v[236:237], v253 offset:24576
v_mfma_f32_16x16x32_bf16 v[4:7], v[224:227], v[192:195], v[4:7]
ds_read_b64_tr_b16 v[238:239], v253 offset:26624
v_xor_b32 v253, 32, v253
v_mfma_f32_16x16x32_bf16 v[12:15], v[224:227], v[196:199], v[12:15]
s_waitcnt lgkmcnt(4)
ds_read_b64_tr_b16 v[224:225], v253 offset:0
v_mfma_f32_16x16x32_bf16 v[20:23], v[228:231], v[192:195], v[20:23]
ds_read_b64_tr_b16 v[226:227], v253 offset:2048
v_mfma_f32_16x16x32_bf16 v[28:31], v[228:231], v[196:199], v[28:31]
s_waitcnt lgkmcnt(4)
ds_read_b64_tr_b16 v[228:229], v253 offset:8192
v_mfma_f32_16x16x32_bf16 v[36:39], v[232:235], v[192:195], v[36:39]
ds_read_b64_tr_b16 v[230:231], v253 offset:10240
v_mfma_f32_16x16x32_bf16 v[44:47], v[232:235], v[196:199], v[44:47]
s_waitcnt lgkmcnt(4)
ds_read_b64_tr_b16 v[232:233], v253 offset:16384
v_mfma_f32_16x16x32_bf16 v[52:55], v[236:239], v[192:195], v[52:55]
s_barrier
ds_read_b64_tr_b16 v[234:235], v253 offset:18432
v_mfma_f32_16x16x32_bf16 v[60:63], v[236:239], v[196:199], v[60:63]
s_waitcnt lgkmcnt(4)
ds_read_b64_tr_b16 v[236:237], v253 offset:24576
v_mfma_f32_16x16x32_bf16 v[0:3], v[224:227], v[192:195], v[0:3]
s_cbranch_vccnz L_stub3
L_back3:
ds_read_b64_tr_b16 v[238:239], v253 offset:26624
v_xor_b32 v252, 65536, v252
v_mfma_f32_16x16x32_bf16 v[8:11], v[224:227], v[196:199], v[8:11]
s_waitcnt lgkmcnt(4)
ds_read_b128 v[224:227], v252 offset:0
v_mfma_f32_16x16x32_bf16 v[16:19], v[228:231], v[192:195], v[16:19]
s_cmp_eq_u32 s86, s49
v_exp_f32 v208, v208
v_mfma_f32_16x16x32_bf16 v[24:27], v[228:231], v[196:199], v[24:27]
s_waitcnt lgkmcnt(3)
ds_read_b128 v[228:231], v252 offset:2048
v_add_f32 v254, v254, v208
v_mfma_f32_16x16x32_bf16 v[32:35], v[232:235], v[192:195], v[32:35]
s_cbranch_scc1 L_mk2
L_mkb2:
v_exp_f32 v209, v209
v_mfma_f32_16x16x32_bf16 v[40:43], v[232:235], v[196:199], v[40:43]
s_waitcnt lgkmcnt(2)
ds_read_b128 v[232:235], v252 offset:8192
v_add_f32 v254, v254, v209
v_mfma_f32_16x16x32_bf16 v[48:51], v[236:239], v[192:195], v[48:51]
s_add_u32 s49, s49, 1
v_exp_f32 v210, v210
v_mfma_f32_16x16x32_bf16 v[56:59], v[236:239], v[196:199], v[56:59]
s_waitcnt lgkmcnt(2)
ds_read_b128 v[236:239], v252 offset:10240
v_cvt_pk_bf16_f32 v208, v208, v209
v_mfma_f32_16x16x32_bf16 v[192:195], v[224:227], v[128:131], v[244:247]
v_exp_f32 v211, v211
v_mfma_f32_16x16x32_bf16 v[200:203], v[224:227], v[132:135], v[248:251]
s_waitcnt lgkmcnt(2)
ds_read_b128 v[224:227], v252 offset:16384
v_add_f32 v254, v254, v210
v_mfma_f32_16x16x32_bf16 v[196:199], v[228:231], v[128:131], v[244:247]
v_exp_f32 v212, v212
v_mfma_f32_16x16x32_bf16 v[204:207], v[228:231], v[132:135], v[248:251]
s_waitcnt lgkmcnt(2)
ds_read_b128 v[228:231], v252 offset:18432
v_cvt_pk_bf16_f32 v209, v210, v211
v_mfma_f32_16x16x32_bf16 v[192:195], v[232:235], v[144:147], v[192:195]
v_exp_f32 v213, v213
v_mfma_f32_16x16x32_bf16 v[200:203], v[232:235], v[148:151], v[200:203]
s_waitcnt lgkmcnt(2)
ds_read_b128 v[232:235], v252 offset:24576
v_add_f32 v254, v254, v211
v_mfma_f32_16x16x32_bf16 v[196:199], v[236:239], v[144:147], v[196:199]
v_exp_f32 v214, v214
v_mfma_f32_16x16x32_bf16 v[204:207], v[236:239], v[148:151], v[204:207]
s_waitcnt lgkmcnt(2)
ds_read_b128 v[236:239], v252 offset:26624
v_xor_b32 v252, 64, v252
v_mfma_f32_16x16x32_bf16 v[192:195], v[224:227], v[160:163], v[192:195]
v_exp_f32 v215, v215
v_mfma_f32_16x16x32_bf16 v[200:203], v[224:227], v[164:167], v[200:203]
s_waitcnt lgkmcnt(2)
ds_read_b128 v[224:227], v252 offset:0
v_cvt_pk_bf16_f32 v210, v212, v213
v_mfma_f32_16x16x32_bf16 v[196:199], v[228:231], v[160:163], v[196:199]
v_exp_f32 v216, v216
v_mfma_f32_16x16x32_bf16 v[204:207], v[228:231], v[164:167], v[204:207]
s_waitcnt lgkmcnt(2)
ds_read_b128 v[228:231], v252 offset:2048
v_add_f32 v254, v254, v212
v_mfma_f32_16x16x32_bf16 v[192:195], v[232:235], v[176:179], v[192:195]
v_exp_f32 v217, v217
v_mfma_f32_16x16x32_bf16 v[200:203], v[232:235], v[180:183], v[200:203]
s_waitcnt lgkmcnt(2)
ds_read_b128 v[232:235], v252 offset:8192
v_cvt_pk_bf16_f32 v211, v214, v215
v_mfma_f32_16x16x32_bf16 v[196:199], v[236:239], v[176:179], v[196:199]
v_exp_f32 v218, v218
v_mfma_f32_16x16x32_bf16 v[204:207], v[236:239], v[180:183], v[204:207]
s_waitcnt lgkmcnt(2)
ds_read_b128 v[236:239], v252 offset:10240
v_add_f32 v254, v254, v213
v_mfma_f32_16x16x32_bf16 v[192:195], v[224:227], v[136:139], v[192:195]
v_exp_f32 v219, v219
v_mfma_f32_16x16x32_bf16 v[200:203], v[224:227], v[140:143], v[200:203]
s_waitcnt lgkmcnt(2)
ds_read_b128 v[224:227], v252 offset:16384
v_cvt_pk_bf16_f32 v212, v216, v217
v_mfma_f32_16x16x32_bf16 v[196:199], v[228:231], v[136:139], v[196:199]
v_exp_f32 v220, v220
v_mfma_f32_16x16x32_bf16 v[204:207], v[228:231], v[140:143], v[204:207]
s_waitcnt lgkmcnt(2)
ds_read_b128 v[228:231], v252 offset:18432
v_add_f32 v254, v254, v214
v_mfma_f32_16x16x32_bf16 v[192:195], v[232:235], v[152:155], v[192:195]
v_exp_f32 v221, v221
v_mfma_f32_16x16x32_bf16 v[200:203], v[232:235], v[156:159], v[200:203]
s_waitcnt lgkmcnt(2)
ds_read_b128 v[232:235], v252 offset:24576
v_cvt_pk_bf16_f32 v213, v218, v219
v_mfma_f32_16x16x32_bf16 v[196:199], v[236:239], v[152:155], v[196:199]
s_barrier
v_exp_f32 v222, v222
v_mfma_f32_16x16x32_bf16 v[204:207], v[236:239], v[156:159], v[204:207]
s_waitcnt lgkmcnt(2)
ds_read_b128 v[236:239], v252 offset:26624
v_xor_b32 v253, s41, v253
v_mfma_f32_16x16x32_bf16 v[192:195], v[224:227], v[168:171], v[192:195]
v_exp_f32 v223, v223
v_mfma_f32_16x16x32_bf16 v[200:203], v[224:227], v[172:175], v[200:203]
s_waitcnt lgkmcnt(2)
ds_read_b64_tr_b16 v[224:225], v253 offset:0
v_add_f32 v254, v254, v215
v_mfma_f32_16x16x32_bf16 v[196:199], v[228:231], v[168:171], v[196:199]
ds_read_b64_tr_b16 v[226:227], v253 offset:2048
v_cvt_pk_bf16_f32 v214, v220, v221
v_mfma_f32_16x16x32_bf16 v[204:207], v[228:231], v[172:175], v[204:207]
s_waitcnt lgkmcnt(3)
ds_read_b64_tr_b16 v[228:229], v253 offset:8192
v_add_f32 v255, v255, v216
v_mfma_f32_16x16x32_bf16 v[192:195], v[232:235], v[184:187], v[192:195]
ds_read_b64_tr_b16 v[230:231], v253 offset:10240
v_add_f32 v255, v255, v217
v_mfma_f32_16x16x32_bf16 v[200:203], v[232:235], v[188:191], v[200:203]
s_waitcnt lgkmcnt(4)
ds_read_b64_tr_b16 v[232:233], v253 offset:16384
v_cvt_pk_bf16_f32 v215, v222, v223
v_mfma_f32_16x16x32_bf16 v[196:199], v[236:239], v[184:187], v[196:199]
ds_read_b64_tr_b16 v[234:235], v253 offset:18432
v_add_f32 v255, v255, v218
v_mfma_f32_16x16x32_bf16 v[204:207], v[236:239], v[188:191], v[204:207]
s_waitcnt lgkmcnt(4)
ds_read_b64_tr_b16 v[236:237], v253 offset:24576
v_add_f32 v255, v255, v219
v_mfma_f32_16x16x32_bf16 v[64:67], v[224:227], v[208:211], v[64:67]
ds_read_b64_tr_b16 v[238:239], v253 offset:26624
v_xor_b32 v253, 32, v253
v_mfma_f32_16x16x32_bf16 v[72:75], v[224:227], v[212:215], v[72:75]
s_waitcnt lgkmcnt(4)
ds_read_b64_tr_b16 v[224:225], v253 offset:0
v_add_f32 v255, v255, v220
v_mfma_f32_16x16x32_bf16 v[80:83], v[228:231], v[208:211], v[80:83]
s_xor_b32 s41, s40, s41
ds_read_b64_tr_b16 v[226:227], v253 offset:2048
v_add_f32 v255, v255, v221
v_mfma_f32_16x16x32_bf16 v[88:91], v[228:231], v[212:215], v[88:91]
s_waitcnt lgkmcnt(4)
ds_read_b64_tr_b16 v[228:229], v253 offset:8192
v_add_f32 v255, v255, v222
v_mfma_f32_16x16x32_bf16 v[96:99], v[232:235], v[208:211], v[96:99]
s_xor_b32 s41, 64, s41
ds_read_b64_tr_b16 v[230:231], v253 offset:10240
v_add_f32 v255, v255, v223
v_mfma_f32_16x16x32_bf16 v[104:107], v[232:235], v[212:215], v[104:107]
s_waitcnt lgkmcnt(4)
ds_read_b64_tr_b16 v[232:233], v253 offset:16384
v_max3_f32 v216, v192, v193, v194
v_mfma_f32_16x16x32_bf16 v[112:115], v[236:239], v[208:211], v[112:115]
ds_read_b64_tr_b16 v[234:235], v253 offset:18432
v_max3_f32 v216, v216, v195, v196
v_mfma_f32_16x16x32_bf16 v[120:123], v[236:239], v[212:215], v[120:123]
s_waitcnt lgkmcnt(4)
ds_read_b64_tr_b16 v[236:237], v253 offset:24576
v_max3_f32 v216, v216, v197, v198
v_mfma_f32_16x16x32_bf16 v[68:71], v[224:227], v[208:211], v[68:71]
ds_read_b64_tr_b16 v[238:239], v253 offset:26624
v_xor_b32 v253, 64, v253
v_mfma_f32_16x16x32_bf16 v[76:79], v[224:227], v[212:215], v[76:79]
s_waitcnt lgkmcnt(4)
ds_read_b64_tr_b16 v[224:225], v253 offset:0
v_max3_f32 v216, v216, v199, v200
v_mfma_f32_16x16x32_bf16 v[84:87], v[228:231], v[208:211], v[84:87]
ds_read_b64_tr_b16 v[226:227], v253 offset:2048
v_max3_f32 v216, v216, v201, v202
v_mfma_f32_16x16x32_bf16 v[92:95], v[228:231], v[212:215], v[92:95]
s_waitcnt lgkmcnt(4)
ds_read_b64_tr_b16 v[228:229], v253 offset:8192
v_max3_f32 v216, v216, v203, v204
v_mfma_f32_16x16x32_bf16 v[100:103], v[232:235], v[208:211], v[100:103]
ds_read_b64_tr_b16 v[230:231], v253 offset:10240
v_max3_f32 v216, v216, v205, v206
v_mfma_f32_16x16x32_bf16 v[108:111], v[232:235], v[212:215], v[108:111]
s_waitcnt lgkmcnt(4)
ds_read_b64_tr_b16 v[232:233], v253 offset:16384
v_max_f32 v216, v216, v207
v_mfma_f32_16x16x32_bf16 v[116:119], v[236:239], v[208:211], v[116:119]
ds_read_b64_tr_b16 v[234:235], v253 offset:18432
v_cmp_lt_f32 vcc, s39, v216
v_mfma_f32_16x16x32_bf16 v[124:127], v[236:239], v[212:215], v[124:127]
s_waitcnt lgkmcnt(4)
ds_read_b64_tr_b16 v[236:237], v253 offset:24576
v_mfma_f32_16x16x32_bf16 v[4:7], v[224:227], v[208:211], v[4:7]
ds_read_b64_tr_b16 v[238:239], v253 offset:26624
v_xor_b32 v253, 32, v253
v_mfma_f32_16x16x32_bf16 v[12:15], v[224:227], v[212:215], v[12:15]
s_waitcnt lgkmcnt(4)
ds_read_b64_tr_b16 v[224:225], v253 offset:0
v_mfma_f32_16x16x32_bf16 v[20:23], v[228:231], v[208:211], v[20:23]
ds_read_b64_tr_b16 v[226:227], v253 offset:2048
v_mfma_f32_16x16x32_bf16 v[28:31], v[228:231], v[212:215], v[28:31]
s_waitcnt lgkmcnt(4)
ds_read_b64_tr_b16 v[228:229], v253 offset:8192
v_mfma_f32_16x16x32_bf16 v[36:39], v[232:235], v[208:211], v[36:39]
ds_read_b64_tr_b16 v[230:231], v253 offset:10240
v_mfma_f32_16x16x32_bf16 v[44:47], v[232:235], v[212:215], v[44:47]
s_waitcnt lgkmcnt(4)
ds_read_b64_tr_b16 v[232:233], v253 offset:16384
v_mfma_f32_16x16x32_bf16 v[52:55], v[236:239], v[208:211], v[52:55]
s_barrier
ds_read_b64_tr_b16 v[234:235], v253 offset:18432
v_mfma_f32_16x16x32_bf16 v[60:63], v[236:239], v[212:215], v[60:63]
s_waitcnt lgkmcnt(4)
ds_read_b64_tr_b16 v[236:237], v253 offset:24576
v_mfma_f32_16x16x32_bf16 v[0:3], v[224:227], v[208:211], v[0:3]
s_cbranch_vccnz L_stub4
L_back4:
ds_read_b64_tr_b16 v[238:239], v253 offset:26624
v_xor_b32 v252, 65536, v252
v_mfma_f32_16x16x32_bf16 v[8:11], v[224:227], v[212:215], v[8:11]
s_waitcnt lgkmcnt(4)
ds_read_b128 v[224:227], v252 offset:0
v_mfma_f32_16x16x32_bf16 v[16:19], v[228:231], v[208:211], v[16:19]
s_cmp_eq_u32 s86, s49
v_exp_f32 v192, v192
v_mfma_f32_16x16x32_bf16 v[24:27], v[228:231], v[212:215], v[24:27]
s_waitcnt lgkmcnt(3)
ds_read_b128 v[228:231], v252 offset:2048
v_add_f32 v254, v254, v192
v_mfma_f32_16x16x32_bf16 v[32:35], v[232:235], v[208:211], v[32:35]
s_cbranch_scc1 L_mk3
L_mkb3:
v_exp_f32 v193, v193
v_mfma_f32_16x16x32_bf16 v[40:43], v[232:235], v[212:215], v[40:43]
s_waitcnt lgkmcnt(2)
ds_read_b128 v[232:235], v252 offset:8192
v_add_f32 v254, v254, v193
v_mfma_f32_16x16x32_bf16 v[48:51], v[236:239], v[208:211], v[48:51]
s_add_u32 s49, s49, 1
v_exp_f32 v194, v194
v_mfma_f32_16x16x32_bf16 v[56:59], v[236:239], v[212:215], v[56:59]
s_waitcnt lgkmcnt(2)
s_cmp_lt_u32 s49, 14
ds_read_b128 v[236:239], v252 offset:10240
v_cvt_pk_bf16_f32 v192, v192, v193
v_mfma_f32_16x16x32_bf16 v[208:211], v[224:227], v[136:139], v[244:247]
s_cbranch_scc1 L_loop
L_post:
v_exp_f32 v195, v195
v_mfma_f32_16x16x32_bf16 v[216:219], v[224:227], v[140:143], v[248:251]
s_waitcnt lgkmcnt(2)
ds_read_b128 v[224:227], v252 offset:16384
v_add_f32 v254, v254, v194
v_mfma_f32_16x16x32_bf16 v[212:215], v[228:231], v[136:139], v[244:247]
v_exp_f32 v196, v196
v_mfma_f32_16x16x32_bf16 v[220:223], v[228:231], v[140:143], v[248:251]
s_waitcnt lgkmcnt(2)
ds_read_b128 v[228:231], v252 offset:18432
v_cvt_pk_bf16_f32 v193, v194, v195
v_mfma_f32_16x16x32_bf16 v[208:211], v[232:235], v[152:155], v[208:211]
v_exp_f32 v197, v197
v_mfma_f32_16x16x32_bf16 v[216:219], v[232:235], v[156:159], v[216:219]
s_waitcnt lgkmcnt(2)
ds_read_b128 v[232:235], v252 offset:24576
v_add_f32 v254, v254, v195
v_mfma_f32_16x16x32_bf16 v[212:215], v[236:239], v[152:155], v[212:215]
v_exp_f32 v198, v198
v_mfma_f32_16x16x32_bf16 v[220:223], v[236:239], v[156:159], v[220:223]
s_waitcnt lgkmcnt(2)
ds_read_b128 v[236:239], v252 offset:26624
v_xor_b32 v252, 64, v252
v_mfma_f32_16x16x32_bf16 v[208:211], v[224:227], v[168:171], v[208:211]
v_exp_f32 v199, v199
v_mfma_f32_16x16x32_bf16 v[216:219], v[224:227], v[172:175], v[216:219]
s_waitcnt lgkmcnt(2)
ds_read_b128 v[224:227], v252 offset:0
v_cvt_pk_bf16_f32 v194, v196, v197
v_mfma_f32_16x16x32_bf16 v[212:215], v[228:231], v[168:171], v[212:215]
v_exp_f32 v200, v200
v_mfma_f32_16x16x32_bf16 v[220:223], v[228:231], v[172:175], v[220:223]
s_waitcnt lgkmcnt(2)
ds_read_b128 v[228:231], v252 offset:2048
v_add_f32 v254, v254, v196
v_mfma_f32_16x16x32_bf16 v[208:211], v[232:235], v[184:187], v[208:211]
v_exp_f32 v201, v201
v_mfma_f32_16x16x32_bf16 v[216:219], v[232:235], v[188:191], v[216:219]
s_waitcnt lgkmcnt(2)
ds_read_b128 v[232:235], v252 offset:8192
v_cvt_pk_bf16_f32 v195, v198, v199
v_mfma_f32_16x16x32_bf16 v[212:215], v[236:239], v[184:187], v[212:215]
v_exp_f32 v202, v202
v_mfma_f32_16x16x32_bf16 v[220:223], v[236:239], v[188:191], v[220:223]
s_waitcnt lgkmcnt(2)
ds_read_b128 v[236:239], v252 offset:10240
v_add_f32 v254, v254, v197
v_mfma_f32_16x16x32_bf16 v[208:211], v[224:227], v[128:131], v[208:211]
v_exp_f32 v203, v203
v_mfma_f32_16x16x32_bf16 v[216:219], v[224:227], v[132:135], v[216:219]
s_waitcnt lgkmcnt(2)
ds_read_b128 v[224:227], v252 offset:16384
v_cvt_pk_bf16_f32 v196, v200, v201
v_mfma_f32_16x16x32_bf16 v[212:215], v[228:231], v[128:131], v[212:215]
v_exp_f32 v204, v204
v_mfma_f32_16x16x32_bf16 v[220:223], v[228:231], v[132:135], v[220:223]
s_waitcnt lgkmcnt(2)
ds_read_b128 v[228:231], v252 offset:18432
v_add_f32 v254, v254, v198
v_mfma_f32_16x16x32_bf16 v[208:211], v[232:235], v[144:147], v[208:211]
v_exp_f32 v205, v205
v_mfma_f32_16x16x32_bf16 v[216:219], v[232:235], v[148:151], v[216:219]
s_waitcnt lgkmcnt(2)
ds_read_b128 v[232:235], v252 offset:24576
v_cvt_pk_bf16_f32 v197, v202, v203
v_mfma_f32_16x16x32_bf16 v[212:215], v[236:239], v[144:147], v[212:215]
s_barrier
v_exp_f32 v206, v206
v_mfma_f32_16x16x32_bf16 v[220:223], v[236:239], v[148:151], v[220:223]
s_waitcnt lgkmcnt(2)
ds_read_b128 v[236:239], v252 offset:26624
v_xor_b32 v253, 229440, v253
v_mfma_f32_16x16x32_bf16 v[208:211], v[224:227], v[160:163], v[208:211]
v_exp_f32 v207, v207
v_mfma_f32_16x16x32_bf16 v[216:219], v[224:227], v[164:167], v[216:219]
s_waitcnt lgkmcnt(2)
ds_read_b64_tr_b16 v[224:225], v253 offset:0
v_add_f32 v254, v254, v199
v_mfma_f32_16x16x32_bf16 v[212:215], v[228:231], v[160:163], v[212:215]
ds_read_b64_tr_b16 v[226:227], v253 offset:2048
v_cvt_pk_bf16_f32 v198, v204, v205
v_mfma_f32_16x16x32_bf16 v[220:223], v[228:231], v[164:167], v[220:223]
s_waitcnt lgkmcnt(3)
ds_read_b64_tr_b16 v[228:229], v253 offset:8192
v_add_f32 v255, v255, v200
v_mfma_f32_16x16x32_bf16 v[208:211], v[232:235], v[176:179], v[208:211]
ds_read_b64_tr_b16 v[230:231], v253 offset:10240
v_add_f32 v255, v255, v201
v_mfma_f32_16x16x32_bf16 v[216:219], v[232:235], v[180:183], v[216:219]
s_waitcnt lgkmcnt(4)
ds_read_b64_tr_b16 v[232:233], v253 offset:16384
v_cvt_pk_bf16_f32 v199, v206, v207
v_mfma_f32_16x16x32_bf16 v[212:215], v[236:239], v[176:179], v[212:215]
ds_read_b64_tr_b16 v[234:235], v253 offset:18432
v_add_f32 v255, v255, v202
v_mfma_f32_16x16x32_bf16 v[220:223], v[236:239], v[180:183], v[220:223]
s_waitcnt lgkmcnt(4)
ds_read_b64_tr_b16 v[236:237], v253 offset:24576
v_add_f32 v255, v255, v203
v_mfma_f32_16x16x32_bf16 v[64:67], v[224:227], v[192:195], v[64:67]
s_lshl_b32 s47, s26, 13
s_add_u32 s50, s47, 0
s_xor_b32 s51, s50, 0x4000
ds_read_b64_tr_b16 v[238:239], v253 offset:26624
v_xor_b32 v253, 32, v253
v_mfma_f32_16x16x32_bf16 v[72:75], v[224:227], v[196:199], v[72:75]
s_waitcnt lgkmcnt(4)
ds_read_b64_tr_b16 v[224:225], v253 offset:0
v_mbcnt_lo_u32_b32 v252, -1, 0
v_mfma_f32_16x16x32_bf16 v[80:83], v[228:231], v[192:195], v[80:83]
ds_read_b64_tr_b16 v[226:227], v253 offset:2048
v_mbcnt_hi_u32_b32 v252, -1, v252
v_mfma_f32_16x16x32_bf16 v[88:91], v[228:231], v[196:199], v[88:91]
s_waitcnt lgkmcnt(4)
ds_read_b64_tr_b16 v[228:229], v253 offset:8192
v_lshlrev_b32 v252, 4, v252
v_add_u32 v177, s51, v252
v_add_u32 v176, s50, v252
v_mfma_f32_16x16x32_bf16 v[96:99], v[232:235], v[192:195], v[96:99]
ds_read_b64_tr_b16 v[230:231], v253 offset:10240
v_add_f32 v255, v255, v204
v_mfma_f32_16x16x32_bf16 v[104:107], v[232:235], v[196:199], v[104:107]
s_waitcnt lgkmcnt(4)
ds_read_b64_tr_b16 v[232:233], v253 offset:16384
v_add_f32 v255, v255, v205
v_add_f32 v255, v255, v206
v_add_f32 v255, v255, v207
v_max3_f32 v200, v208, v209, v210
v_max3_f32 v200, v200, v211, v212
v_mfma_f32_16x16x32_bf16 v[112:115], v[236:239], v[192:195], v[112:115]
ds_read_b64_tr_b16 v[234:235], v253 offset:18432
v_max3_f32 v200, v200, v213, v214
v_mfma_f32_16x16x32_bf16 v[120:123], v[236:239], v[196:199], v[120:123]
s_waitcnt lgkmcnt(4)
ds_read_b64_tr_b16 v[236:237], v253 offset:24576
v_max3_f32 v200, v200, v215, v216
v_mfma_f32_16x16x32_bf16 v[68:71], v[224:227], v[192:195], v[68:71]
ds_read_b64_tr_b16 v[238:239], v253 offset:26624
v_xor_b32 v253, 64, v253
v_max3_f32 v200, v200, v217, v218
v_mfma_f32_16x16x32_bf16 v[76:79], v[224:227], v[196:199], v[76:79]
s_waitcnt lgkmcnt(4)
ds_read_b64_tr_b16 v[224:225], v253 offset:0
v_max3_f32 v200, v200, v219, v220
v_mfma_f32_16x16x32_bf16 v[84:87], v[228:231], v[192:195], v[84:87]
ds_read_b64_tr_b16 v[226:227], v253 offset:2048
v_max3_f32 v200, v200, v221, v222
v_mfma_f32_16x16x32_bf16 v[92:95], v[228:231], v[196:199], v[92:95]
s_waitcnt lgkmcnt(4)
ds_read_b64_tr_b16 v[228:229], v253 offset:8192
v_max_f32 v200, v200, v223
v_mfma_f32_16x16x32_bf16 v[100:103], v[232:235], v[192:195], v[100:103]
ds_read_b64_tr_b16 v[230:231], v253 offset:10240
v_cmp_lt_f32 vcc, s39, v200
v_mfma_f32_16x16x32_bf16 v[108:111], v[232:235], v[196:199], v[108:111]
s_waitcnt lgkmcnt(4)
s_cbranch_vccnz L_stub15
L_back15:
ds_read_b64_tr_b16 v[232:233], v253 offset:16384
v_exp_f32 v208, v208
v_mfma_f32_16x16x32_bf16 v[116:119], v[236:239], v[192:195], v[116:119]
ds_read_b64_tr_b16 v[234:235], v253 offset:18432
v_add_f32 v254, v254, v208
v_exp_f32 v209, v209
v_mfma_f32_16x16x32_bf16 v[124:127], v[236:239], v[196:199], v[124:127]
s_waitcnt lgkmcnt(4)
s_cmp_eq_u32 s86, 14
ds_read_b64_tr_b16 v[236:237], v253 offset:24576
v_add_f32 v254, v254, v209
v_exp_f32 v210, v210
v_mfma_f32_16x16x32_bf16 v[4:7], v[224:227], v[192:195], v[4:7]
ds_read_b64_tr_b16 v[238:239], v253 offset:26624
v_xor_b32 v253, 32, v253
v_exp_f32 v211, v211
v_mfma_f32_16x16x32_bf16 v[12:15], v[224:227], v[196:199], v[12:15]
s_waitcnt lgkmcnt(4)
s_cbranch_scc1 L_mk14
L_mkb14:
ds_read_b64_tr_b16 v[224:225], v253 offset:0
v_cvt_pk_bf16_f32 v208, v208, v209
v_exp_f32 v212, v212
v_mfma_f32_16x16x32_bf16 v[20:23], v[228:231], v[192:195], v[20:23]
ds_read_b64_tr_b16 v[226:227], v253 offset:2048
v_add_f32 v254, v254, v210
v_exp_f32 v213, v213
v_mfma_f32_16x16x32_bf16 v[28:31], v[228:231], v[196:199], v[28:31]
s_waitcnt lgkmcnt(4)
ds_read_b64_tr_b16 v[228:229], v253 offset:8192
v_cvt_pk_bf16_f32 v209, v210, v211
v_exp_f32 v214, v214
v_mfma_f32_16x16x32_bf16 v[36:39], v[232:235], v[192:195], v[36:39]
ds_read_b64_tr_b16 v[230:231], v253 offset:10240
v_add_f32 v254, v254, v211
v_exp_f32 v215, v215
v_mfma_f32_16x16x32_bf16 v[44:47], v[232:235], v[196:199], v[44:47]
s_waitcnt lgkmcnt(4)
ds_read_b64_tr_b16 v[232:233], v253 offset:16384
v_cvt_pk_bf16_f32 v210, v212, v213
v_exp_f32 v216, v216
v_mfma_f32_16x16x32_bf16 v[52:55], v[236:239], v[192:195], v[52:55]
s_barrier
ds_read_b64_tr_b16 v[234:235], v253 offset:18432
v_add_f32 v254, v254, v212
v_exp_f32 v217, v217
v_mfma_f32_16x16x32_bf16 v[60:63], v[236:239], v[196:199], v[60:63]
s_waitcnt lgkmcnt(4)
ds_read_b64_tr_b16 v[236:237], v253 offset:24576
v_cvt_pk_bf16_f32 v211, v214, v215
v_exp_f32 v218, v218
v_mfma_f32_16x16x32_bf16 v[0:3], v[224:227], v[192:195], v[0:3]
ds_read_b64_tr_b16 v[238:239], v253 offset:26624
v_xor_b32 v253, 163904, v253
v_exp_f32 v219, v219
v_mfma_f32_16x16x32_bf16 v[8:11], v[224:227], v[196:199], v[8:11]
s_waitcnt lgkmcnt(4)
ds_read_b64_tr_b16 v[224:225], v253 offset:0
v_add_f32 v254, v254, v213
v_exp_f32 v220, v220
v_mfma_f32_16x16x32_bf16 v[16:19], v[228:231], v[192:195], v[16:19]
ds_read_b64_tr_b16 v[226:227], v253 offset:2048
v_cvt_pk_bf16_f32 v212, v216, v217
v_exp_f32 v221, v221
v_mfma_f32_16x16x32_bf16 v[24:27], v[228:231], v[196:199], v[24:27]
s_waitcnt lgkmcnt(4)
ds_read_b64_tr_b16 v[228:229], v253 offset:8192
v_add_f32 v254, v254, v214
v_exp_f32 v222, v222
v_mfma_f32_16x16x32_bf16 v[32:35], v[232:235], v[192:195], v[32:35]
ds_read_b64_tr_b16 v[230:231], v253 offset:10240
v_cvt_pk_bf16_f32 v213, v218, v219
v_exp_f32 v223, v223
v_add_f32 v254, v254, v215
v_mfma_f32_16x16x32_bf16 v[40:43], v[232:235], v[196:199], v[40:43]
s_waitcnt lgkmcnt(4)
ds_read_b64_tr_b16 v[232:233], v253 offset:16384
v_cvt_pk_bf16_f32 v214, v220, v221
v_add_f32 v255, v255, v216
v_add_f32 v255, v255, v217
v_mfma_f32_16x16x32_bf16 v[48:51], v[236:239], v[192:195], v[48:51]
L_tail:
ds_read_b64_tr_b16 v[234:235], v253 offset:18432
v_cvt_pk_bf16_f32 v215, v222, v223
v_mfma_f32_16x16x32_bf16 v[56:59], v[236:239], v[196:199], v[56:59]
s_waitcnt lgkmcnt(4)
ds_read_b64_tr_b16 v[236:237], v253 offset:24576
v_add_f32 v255, v255, v218
v_mfma_f32_16x16x32_bf16 v[64:67], v[224:227], v[208:211], v[64:67]
ds_read_b64_tr_b16 v[238:239], v253 offset:26624
v_xor_b32 v253, 32, v253
v_add_f32 v255, v255, v219
v_add_f32 v255, v255, v220
v_add_f32 v255, v255, v221
v_add_f32 v255, v255, v222
v_add_f32 v255, v255, v223
v_mfma_f32_16x16x32_bf16 v[72:75], v[224:227], v[212:215], v[72:75]
s_waitcnt lgkmcnt(4)
ds_read_b64_tr_b16 v[224:225], v253 offset:0
v_mov_b32 v182, v254
v_mov_b32 v183, v255
s_nop 0
v_permlane32_swap_b32 v254, v182
v_mfma_f32_16x16x32_bf16 v[80:83], v[228:231], v[208:211], v[80:83]
ds_read_b64_tr_b16 v[226:227], v253 offset:2048
v_permlane32_swap_b32 v255, v183
v_add_f32 v254, v254, v182
v_add_f32 v255, v255, v183
v_mov_b32 v182, v254
v_mfma_f32_16x16x32_bf16 v[88:91], v[228:231], v[212:215], v[88:91]
s_waitcnt lgkmcnt(4)
ds_read_b64_tr_b16 v[228:229], v253 offset:8192
v_mov_b32 v183, v255
s_nop 0
v_permlane16_swap_b32 v254, v182
v_permlane16_swap_b32 v255, v183
v_mfma_f32_16x16x32_bf16 v[96:99], v[232:235], v[208:211], v[96:99]
ds_read_b64_tr_b16 v[230:231], v253 offset:10240
v_add_f32 v254, v254, v182
v_add_f32 v255, v255, v183
v_mov_b32 v172, v244
v_mov_b32 v173, v254
v_mfma_f32_16x16x32_bf16 v[104:107], v[232:235], v[212:215], v[104:107]
s_waitcnt lgkmcnt(4)
ds_read_b64_tr_b16 v[232:233], v253 offset:16384
v_mov_b32 v174, v248
v_mov_b32 v175, v255
ds_write_b128 v177, v[172:175]
v_mfma_f32_16x16x32_bf16 v[112:115], v[236:239], v[208:211], v[112:115]
ds_read_b64_tr_b16 v[234:235], v253 offset:18432
v_mfma_f32_16x16x32_bf16 v[120:123], v[236:239], v[212:215], v[120:123]
s_waitcnt lgkmcnt(5)
ds_read_b64_tr_b16 v[236:237], v253 offset:24576
v_mfma_f32_16x16x32_bf16 v[68:71], v[224:227], v[208:211], v[68:71]
s_waitcnt lgkmcnt(2)
s_barrier
ds_read_b128 v[184:187], v176
ds_read_b64_tr_b16 v[238:239], v253 offset:26624
v_xor_b32 v253, 64, v253
v_mfma_f32_16x16x32_bf16 v[76:79], v[224:227], v[212:215], v[76:79]
ds_read_b64_tr_b16 v[224:225], v253 offset:0
v_mfma_f32_16x16x32_bf16 v[84:87], v[228:231], v[208:211], v[84:87]
ds_read_b64_tr_b16 v[226:227], v253 offset:2048
v_mfma_f32_16x16x32_bf16 v[92:95], v[228:231], v[212:215], v[92:95]
s_waitcnt lgkmcnt(5)
ds_read_b64_tr_b16 v[228:229], v253 offset:8192
v_mfma_f32_16x16x32_bf16 v[100:103], v[232:235], v[208:211], v[100:103]
ds_read_b64_tr_b16 v[230:231], v253 offset:10240
s_waitcnt lgkmcnt(5)
v_min_f32 v188, v244, v184
v_min_f32 v190, v248, v186
v_mfma_f32_16x16x32_bf16 v[108:111], v[232:235], v[212:215], v[108:111]
s_waitcnt lgkmcnt(4)
ds_read_b64_tr_b16 v[232:233], v253 offset:16384
v_sub_f32 v189, v188, v184
v_sub_f32 v191, v190, v186
v_mfma_f32_16x16x32_bf16 v[116:119], v[236:239], v[208:211], v[116:119]
ds_read_b64_tr_b16 v[234:235], v253 offset:18432
v_sub_f32 v188, v188, v244
v_sub_f32 v190, v190, v248
v_mfma_f32_16x16x32_bf16 v[124:127], v[236:239], v[212:215], v[124:127]
s_waitcnt lgkmcnt(4)
ds_read_b64_tr_b16 v[236:237], v253 offset:24576
v_exp_f32 v188, v188
v_exp_f32 v190, v190
v_mfma_f32_16x16x32_bf16 v[4:7], v[224:227], v[208:211], v[4:7]
ds_read_b64_tr_b16 v[238:239], v253 offset:26624
v_xor_b32 v253, 32, v253
v_exp_f32 v189, v189
v_exp_f32 v191, v191
v_mfma_f32_16x16x32_bf16 v[12:15], v[224:227], v[212:215], v[12:15]
s_waitcnt lgkmcnt(4)
ds_read_b64_tr_b16 v[224:225], v253 offset:0
v_mul_f32 v184, v254, v188
v_mul_f32 v186, v255, v190
v_mfma_f32_16x16x32_bf16 v[20:23], v[228:231], v[208:211], v[20:23]
ds_read_b64_tr_b16 v[226:227], v253 offset:2048
v_fma_f32 v184, v185, v189, v184
v_fma_f32 v186, v187, v191, v186
v_mfma_f32_16x16x32_bf16 v[28:31], v[228:231], v[212:215], v[28:31]
s_waitcnt lgkmcnt(4)
ds_read_b64_tr_b16 v[228:229], v253 offset:8192
v_rcp_f32 v184, v184
v_rcp_f32 v186, v186
v_mfma_f32_16x16x32_bf16 v[36:39], v[232:235], v[208:211], v[36:39]
ds_read_b64_tr_b16 v[230:231], v253 offset:10240
v_mul_f32 v178, v188, v184
v_mul_f32 v180, v190, v186
v_mfma_f32_16x16x32_bf16 v[44:47], v[232:235], v[212:215], v[44:47]
s_waitcnt lgkmcnt(4)
ds_read_b64_tr_b16 v[232:233], v253 offset:16384
v_pk_mul_f32 v[64:65], v[64:65], v[178:179] op_sel_hi:[1,0]
v_mfma_f32_16x16x32_bf16 v[52:55], v[236:239], v[208:211], v[52:55]
ds_read_b64_tr_b16 v[234:235], v253 offset:18432
v_pk_mul_f32 v[66:67], v[66:67], v[178:179] op_sel_hi:[1,0]
v_mfma_f32_16x16x32_bf16 v[60:63], v[236:239], v[212:215], v[60:63]
s_waitcnt lgkmcnt(4)
ds_read_b64_tr_b16 v[236:237], v253 offset:24576
v_pk_mul_f32 v[68:69], v[68:69], v[178:179] op_sel_hi:[1,0]
v_mfma_f32_16x16x32_bf16 v[0:3], v[224:227], v[208:211], v[0:3]
ds_read_b64_tr_b16 v[238:239], v253 offset:26624
v_pk_mul_f32 v[70:71], v[70:71], v[178:179] op_sel_hi:[1,0]
v_mfma_f32_16x16x32_bf16 v[8:11], v[224:227], v[212:215], v[8:11]
s_waitcnt lgkmcnt(4)
v_cvt_pk_bf16_f32 v64, v64, v65
v_cvt_pk_bf16_f32 v65, v66, v67
v_mfma_f32_16x16x32_bf16 v[16:19], v[228:231], v[208:211], v[16:19]
v_cvt_pk_bf16_f32 v66, v68, v69
v_cvt_pk_bf16_f32 v67, v70, v71
v_mfma_f32_16x16x32_bf16 v[24:27], v[228:231], v[212:215], v[24:27]
s_waitcnt lgkmcnt(2)
ds_write_b128 v176, v[64:67] offset:0
v_pk_mul_f32 v[72:73], v[72:73], v[180:181] op_sel_hi:[1,0]
v_mfma_f32_16x16x32_bf16 v[32:35], v[232:235], v[208:211], v[32:35]
v_pk_mul_f32 v[74:75], v[74:75], v[180:181] op_sel_hi:[1,0]
v_pk_mul_f32 v[76:77], v[76:77], v[180:181] op_sel_hi:[1,0]
v_mfma_f32_16x16x32_bf16 v[40:43], v[232:235], v[212:215], v[40:43]
s_waitcnt lgkmcnt(1)
v_pk_mul_f32 v[78:79], v[78:79], v[180:181] op_sel_hi:[1,0]
v_cvt_pk_bf16_f32 v72, v72, v73
v_mfma_f32_16x16x32_bf16 v[48:51], v[236:239], v[208:211], v[48:51]
v_cvt_pk_bf16_f32 v73, v74, v75
v_cvt_pk_bf16_f32 v74, v76, v77
v_mfma_f32_16x16x32_bf16 v[56:59], v[236:239], v[212:215], v[56:59]
v_cvt_pk_bf16_f32 v75, v78, v79
ds_write_b128 v176, v[72:75] offset:1024
v_pk_mul_f32 v[80:81], v[80:81], v[178:179] op_sel_hi:[1,0]
v_pk_mul_f32 v[82:83], v[82:83], v[178:179] op_sel_hi:[1,0]
v_pk_mul_f32 v[84:85], v[84:85], v[178:179] op_sel_hi:[1,0]
v_pk_mul_f32 v[86:87], v[86:87], v[178:179] op_sel_hi:[1,0]
v_cvt_pk_bf16_f32 v80, v80, v81
v_cvt_pk_bf16_f32 v81, v82, v83
v_cvt_pk_bf16_f32 v82, v84, v85
v_cvt_pk_bf16_f32 v83, v86, v87
ds_write_b128 v176, v[80:83] offset:2048
v_pk_mul_f32 v[88:89], v[88:89], v[180:181] op_sel_hi:[1,0]
v_pk_mul_f32 v[90:91], v[90:91], v[180:181] op_sel_hi:[1,0]
v_pk_mul_f32 v[92:93], v[92:93], v[180:181] op_sel_hi:[1,0]
v_pk_mul_f32 v[94:95], v[94:95], v[180:181] op_sel_hi:[1,0]
v_cvt_pk_bf16_f32 v88, v88, v89
v_cvt_pk_bf16_f32 v89, v90, v91
v_cvt_pk_bf16_f32 v90, v92, v93
v_cvt_pk_bf16_f32 v91, v94, v95
ds_write_b128 v176, v[88:91] offset:3072
v_pk_mul_f32 v[96:97], v[96:97], v[178:179] op_sel_hi:[1,0]
v_pk_mul_f32 v[98:99], v[98:99], v[178:179] op_sel_hi:[1,0]
v_pk_mul_f32 v[100:101], v[100:101], v[178:179] op_sel_hi:[1,0]
v_pk_mul_f32 v[102:103], v[102:103], v[178:179] op_sel_hi:[1,0]
v_cvt_pk_bf16_f32 v96, v96, v97
v_cvt_pk_bf16_f32 v97, v98, v99
v_cvt_pk_bf16_f32 v98, v100, v101
v_cvt_pk_bf16_f32 v99, v102, v103
ds_write_b128 v176, v[96:99] offset:4096
v_pk_mul_f32 v[104:105], v[104:105], v[180:181] op_sel_hi:[1,0]
v_pk_mul_f32 v[106:107], v[106:107], v[180:181] op_sel_hi:[1,0]
v_pk_mul_f32 v[108:109], v[108:109], v[180:181] op_sel_hi:[1,0]
v_pk_mul_f32 v[110:111], v[110:111], v[180:181] op_sel_hi:[1,0]
v_cvt_pk_bf16_f32 v104, v104, v105
v_cvt_pk_bf16_f32 v105, v106, v107
v_cvt_pk_bf16_f32 v106, v108, v109
v_cvt_pk_bf16_f32 v107, v110, v111
ds_write_b128 v176, v[104:107] offset:5120
v_pk_mul_f32 v[112:113], v[112:113], v[178:179] op_sel_hi:[1,0]
v_pk_mul_f32 v[114:115], v[114:115], v[178:179] op_sel_hi:[1,0]
v_pk_mul_f32 v[116:117], v[116:117], v[178:179] op_sel_hi:[1,0]
v_pk_mul_f32 v[118:119], v[118:119], v[178:179] op_sel_hi:[1,0]
v_cvt_pk_bf16_f32 v112, v112, v113
v_cvt_pk_bf16_f32 v113, v114, v115
v_cvt_pk_bf16_f32 v114, v116, v117
v_cvt_pk_bf16_f32 v115, v118, v119
ds_write_b128 v176, v[112:115] offset:6144
v_pk_mul_f32 v[120:121], v[120:121], v[180:181] op_sel_hi:[1,0]
v_pk_mul_f32 v[122:123], v[122:123], v[180:181] op_sel_hi:[1,0]
v_pk_mul_f32 v[124:125], v[124:125], v[180:181] op_sel_hi:[1,0]
v_pk_mul_f32 v[126:127], v[126:127], v[180:181] op_sel_hi:[1,0]
v_cvt_pk_bf16_f32 v120, v120, v121
v_cvt_pk_bf16_f32 v121, v122, v123
v_cvt_pk_bf16_f32 v122, v124, v125
v_cvt_pk_bf16_f32 v123, v126, v127
ds_write_b128 v176, v[120:123] offset:7168
s_waitcnt lgkmcnt(0)
s_barrier
ds_read_b128 v[128:131], v177 offset:0
ds_read_b128 v[132:135], v177 offset:1024
ds_read_b128 v[136:139], v177 offset:2048
ds_read_b128 v[140:143], v177 offset:3072
ds_read_b128 v[144:147], v177 offset:4096
ds_read_b128 v[148:151], v177 offset:5120
ds_read_b128 v[152:155], v177 offset:6144
ds_read_b128 v[156:159], v177 offset:7168
s_waitcnt lgkmcnt(7)
v_lshlrev_b32 v160, 16, v128
v_and_b32 v161, s63, v128
v_lshlrev_b32 v162, 16, v129
v_and_b32 v163, s63, v129
v_lshlrev_b32 v164, 16, v130
v_and_b32 v165, s63, v130
v_lshlrev_b32 v166, 16, v131
v_and_b32 v167, s63, v131
v_pk_fma_f32 v[0:1], v[0:1], v[178:179], v[160:161] op_sel_hi:[1,0,1]
v_pk_fma_f32 v[2:3], v[2:3], v[178:179], v[162:163] op_sel_hi:[1,0,1]
v_pk_fma_f32 v[4:5], v[4:5], v[178:179], v[164:165] op_sel_hi:[1,0,1]
v_pk_fma_f32 v[6:7], v[6:7], v[178:179], v[166:167] op_sel_hi:[1,0,1]
v_cvt_pk_bf16_f32 v64, v0, v1
v_cvt_pk_bf16_f32 v65, v2, v3
v_cvt_pk_bf16_f32 v66, v4, v5
v_cvt_pk_bf16_f32 v67, v6, v7
ds_write_b128 v177, v[64:67] offset:0
s_waitcnt lgkmcnt(7)
v_lshlrev_b32 v168, 16, v132
v_and_b32 v169, s63, v132
v_lshlrev_b32 v170, 16, v133
v_and_b32 v171, s63, v133
v_lshlrev_b32 v172, 16, v134
v_and_b32 v173, s63, v134
v_lshlrev_b32 v174, 16, v135
v_and_b32 v175, s63, v135
v_pk_fma_f32 v[8:9], v[8:9], v[180:181], v[168:169] op_sel_hi:[1,0,1]
v_pk_fma_f32 v[10:11], v[10:11], v[180:181], v[170:171] op_sel_hi:[1,0,1]
v_pk_fma_f32 v[12:13], v[12:13], v[180:181], v[172:173] op_sel_hi:[1,0,1]
v_pk_fma_f32 v[14:15], v[14:15], v[180:181], v[174:175] op_sel_hi:[1,0,1]
v_cvt_pk_bf16_f32 v68, v8, v9
v_cvt_pk_bf16_f32 v69, v10, v11
v_cvt_pk_bf16_f32 v70, v12, v13
v_cvt_pk_bf16_f32 v71, v14, v15
ds_write_b128 v177, v[68:71] offset:1024
s_waitcnt lgkmcnt(7)
v_lshlrev_b32 v160, 16, v136
v_and_b32 v161, s63, v136
v_lshlrev_b32 v162, 16, v137
v_and_b32 v163, s63, v137
v_lshlrev_b32 v164, 16, v138
v_and_b32 v165, s63, v138
v_lshlrev_b32 v166, 16, v139
v_and_b32 v167, s63, v139
v_pk_fma_f32 v[16:17], v[16:17], v[178:179], v[160:161] op_sel_hi:[1,0,1]
v_pk_fma_f32 v[18:19], v[18:19], v[178:179], v[162:163] op_sel_hi:[1,0,1]
v_pk_fma_f32 v[20:21], v[20:21], v[178:179], v[164:165] op_sel_hi:[1,0,1]
v_pk_fma_f32 v[22:23], v[22:23], v[178:179], v[166:167] op_sel_hi:[1,0,1]
v_cvt_pk_bf16_f32 v72, v16, v17
v_cvt_pk_bf16_f32 v73, v18, v19
v_cvt_pk_bf16_f32 v74, v20, v21
v_cvt_pk_bf16_f32 v75, v22, v23
ds_write_b128 v177, v[72:75] offset:2048
s_waitcnt lgkmcnt(7)
v_lshlrev_b32 v168, 16, v140
v_and_b32 v169, s63, v140
v_lshlrev_b32 v170, 16, v141
v_and_b32 v171, s63, v141
v_lshlrev_b32 v172, 16, v142
v_and_b32 v173, s63, v142
v_lshlrev_b32 v174, 16, v143
v_and_b32 v175, s63, v143
v_pk_fma_f32 v[24:25], v[24:25], v[180:181], v[168:169] op_sel_hi:[1,0,1]
v_pk_fma_f32 v[26:27], v[26:27], v[180:181], v[170:171] op_sel_hi:[1,0,1]
v_pk_fma_f32 v[28:29], v[28:29], v[180:181], v[172:173] op_sel_hi:[1,0,1]
v_pk_fma_f32 v[30:31], v[30:31], v[180:181], v[174:175] op_sel_hi:[1,0,1]
v_cvt_pk_bf16_f32 v76, v24, v25
v_cvt_pk_bf16_f32 v77, v26, v27
v_cvt_pk_bf16_f32 v78, v28, v29
v_cvt_pk_bf16_f32 v79, v30, v31
ds_write_b128 v177, v[76:79] offset:3072
s_waitcnt lgkmcnt(7)
v_lshlrev_b32 v160, 16, v144
v_and_b32 v161, s63, v144
v_lshlrev_b32 v162, 16, v145
v_and_b32 v163, s63, v145
v_lshlrev_b32 v164, 16, v146
v_and_b32 v165, s63, v146
v_lshlrev_b32 v166, 16, v147
v_and_b32 v167, s63, v147
v_pk_fma_f32 v[32:33], v[32:33], v[178:179], v[160:161] op_sel_hi:[1,0,1]
v_pk_fma_f32 v[34:35], v[34:35], v[178:179], v[162:163] op_sel_hi:[1,0,1]
v_pk_fma_f32 v[36:37], v[36:37], v[178:179], v[164:165] op_sel_hi:[1,0,1]
v_pk_fma_f32 v[38:39], v[38:39], v[178:179], v[166:167] op_sel_hi:[1,0,1]
v_cvt_pk_bf16_f32 v80, v32, v33
v_cvt_pk_bf16_f32 v81, v34, v35
v_cvt_pk_bf16_f32 v82, v36, v37
v_cvt_pk_bf16_f32 v83, v38, v39
ds_write_b128 v177, v[80:83] offset:4096
s_waitcnt lgkmcnt(7)
v_lshlrev_b32 v168, 16, v148
v_and_b32 v169, s63, v148
v_lshlrev_b32 v170, 16, v149
v_and_b32 v171, s63, v149
v_lshlrev_b32 v172, 16, v150
v_and_b32 v173, s63, v150
v_lshlrev_b32 v174, 16, v151
v_and_b32 v175, s63, v151
v_pk_fma_f32 v[40:41], v[40:41], v[180:181], v[168:169] op_sel_hi:[1,0,1]
v_pk_fma_f32 v[42:43], v[42:43], v[180:181], v[170:171] op_sel_hi:[1,0,1]
v_pk_fma_f32 v[44:45], v[44:45], v[180:181], v[172:173] op_sel_hi:[1,0,1]
v_pk_fma_f32 v[46:47], v[46:47], v[180:181], v[174:175] op_sel_hi:[1,0,1]
v_cvt_pk_bf16_f32 v84, v40, v41
v_cvt_pk_bf16_f32 v85, v42, v43
v_cvt_pk_bf16_f32 v86, v44, v45
v_cvt_pk_bf16_f32 v87, v46, v47
ds_write_b128 v177, v[84:87] offset:5120
s_waitcnt lgkmcnt(7)
v_lshlrev_b32 v160, 16, v152
v_and_b32 v161, s63, v152
v_lshlrev_b32 v162, 16, v153
v_and_b32 v163, s63, v153
v_lshlrev_b32 v164, 16, v154
v_and_b32 v165, s63, v154
v_lshlrev_b32 v166, 16, v155
v_and_b32 v167, s63, v155
v_pk_fma_f32 v[48:49], v[48:49], v[178:179], v[160:161] op_sel_hi:[1,0,1]
v_pk_fma_f32 v[50:51], v[50:51], v[178:179], v[162:163] op_sel_hi:[1,0,1]
v_pk_fma_f32 v[52:53], v[52:53], v[178:179], v[164:165] op_sel_hi:[1,0,1]
v_pk_fma_f32 v[54:55], v[54:55], v[178:179], v[166:167] op_sel_hi:[1,0,1]
v_cvt_pk_bf16_f32 v88, v48, v49
v_cvt_pk_bf16_f32 v89, v50, v51
v_cvt_pk_bf16_f32 v90, v52, v53
v_cvt_pk_bf16_f32 v91, v54, v55
ds_write_b128 v177, v[88:91] offset:6144
s_waitcnt lgkmcnt(7)
v_lshlrev_b32 v168, 16, v156
v_and_b32 v169, s63, v156
v_lshlrev_b32 v170, 16, v157
v_and_b32 v171, s63, v157
v_lshlrev_b32 v172, 16, v158
v_and_b32 v173, s63, v158
v_lshlrev_b32 v174, 16, v159
v_and_b32 v175, s63, v159
v_pk_fma_f32 v[56:57], v[56:57], v[180:181], v[168:169] op_sel_hi:[1,0,1]
v_pk_fma_f32 v[58:59], v[58:59], v[180:181], v[170:171] op_sel_hi:[1,0,1]
v_pk_fma_f32 v[60:61], v[60:61], v[180:181], v[172:173] op_sel_hi:[1,0,1]
v_pk_fma_f32 v[62:63], v[62:63], v[180:181], v[174:175] op_sel_hi:[1,0,1]
v_cvt_pk_bf16_f32 v92, v56, v57
v_cvt_pk_bf16_f32 v93, v58, v59
v_cvt_pk_bf16_f32 v94, v60, v61
v_cvt_pk_bf16_f32 v95, v62, v63
ds_write_b128 v177, v[92:95] offset:7168
v_bfe_u32 v250, v252, 4, 4
v_add_u32 v250, s68, v250
global_load_ubyte v254, v250, s[16:17] sc0 sc1
v_xor_b32 v253, 98304, v253
s_waitcnt lgkmcnt(0)
s_barrier
ds_read_b64_tr_b16 v[224:225], v253 offset:0
ds_read_b64_tr_b16 v[226:227], v253 offset:2048
ds_read_b64_tr_b16 v[228:229], v253 offset:8192
ds_read_b64_tr_b16 v[230:231], v253 offset:10240
ds_read_b64_tr_b16 v[232:233], v253 offset:16384
ds_read_b64_tr_b16 v[234:235], v253 offset:18432
ds_read_b64_tr_b16 v[236:237], v253 offset:24576
ds_read_b64_tr_b16 v[238:239], v253 offset:26624
v_xor_b32 v253, 32, v253
ds_read_b64_tr_b16 v[240:241], v253 offset:0
ds_read_b64_tr_b16 v[242:243], v253 offset:2048
ds_read_b64_tr_b16 v[244:245], v253 offset:8192
ds_read_b64_tr_b16 v[246:247], v253 offset:10240
s_waitcnt lgkmcnt(10)
v_mfma_f32_16x16x32_bf16 v[192:195], v[224:227], v[64:67], 0
ds_read_b128 v[96:99], v176 offset:0
v_mfma_f32_16x16x32_bf16 v[200:203], v[224:227], v[68:71], 0
s_waitcnt lgkmcnt(9)
ds_read_b64_tr_b16 v[224:225], v253 offset:16384
ds_read_b128 v[100:103], v176 offset:1024
v_mfma_f32_16x16x32_bf16 v[192:195], v[228:231], v[72:75], v[192:195]
ds_read_b64_tr_b16 v[226:227], v253 offset:18432
ds_read_b128 v[104:107], v176 offset:2048
v_mfma_f32_16x16x32_bf16 v[200:203], v[228:231], v[76:79], v[200:203]
s_waitcnt lgkmcnt(11)
ds_read_b64_tr_b16 v[228:229], v253 offset:24576
ds_read_b128 v[108:111], v176 offset:3072
v_mfma_f32_16x16x32_bf16 v[192:195], v[232:235], v[80:83], v[192:195]
ds_read_b64_tr_b16 v[230:231], v253 offset:26624
v_xor_b32 v253, 4096, v253
ds_read_b128 v[112:115], v176 offset:4096
v_mfma_f32_16x16x32_bf16 v[200:203], v[232:235], v[84:87], v[200:203]
s_waitcnt lgkmcnt(13)
ds_read_b64_tr_b16 v[232:233], v253 offset:0
ds_read_b128 v[116:119], v176 offset:5120
v_mfma_f32_16x16x32_bf16 v[192:195], v[236:239], v[88:91], v[192:195]
s_lshl_b32 s42, s46, 16
ds_read_b64_tr_b16 v[234:235], v253 offset:2048
ds_read_b128 v[120:123], v176 offset:6144
v_mfma_f32_16x16x32_bf16 v[200:203], v[236:239], v[92:95], v[200:203]
s_waitcnt lgkmcnt(15)
ds_read_b64_tr_b16 v[236:237], v253 offset:8192
ds_read_b128 v[124:127], v176 offset:7168
v_mfma_f32_16x16x32_bf16 v[196:199], v[240:243], v[64:67], 0
s_add_u32 s42, s42, s45
ds_read_b64_tr_b16 v[238:239], v253 offset:10240
v_mfma_f32_16x16x32_bf16 v[204:207], v[240:243], v[68:71], 0
s_waitcnt lgkmcnt(15)
ds_read_b64_tr_b16 v[240:241], v253 offset:16384
v_mfma_f32_16x16x32_bf16 v[196:199], v[244:247], v[72:75], v[196:199]
s_sub_u32 s43, s89, s46
ds_read_b64_tr_b16 v[242:243], v253 offset:18432
v_mfma_f32_16x16x32_bf16 v[204:207], v[244:247], v[76:79], v[204:207]
s_waitcnt lgkmcnt(14)
ds_read_b64_tr_b16 v[244:245], v253 offset:24576
v_mfma_f32_16x16x32_bf16 v[196:199], v[224:227], v[80:83], v[196:199]
s_and_b32 s43, s43, 15
ds_read_b64_tr_b16 v[246:247], v253 offset:26624
v_xor_b32 v253, 32, v253
v_mfma_f32_16x16x32_bf16 v[204:207], v[224:227], v[84:87], v[204:207]
s_waitcnt lgkmcnt(12)
ds_read_b64_tr_b16 v[224:225], v253 offset:0
v_mfma_f32_16x16x32_bf16 v[196:199], v[228:231], v[88:91], v[196:199]
s_lshl_b32 s43, s43, 10
ds_read_b64_tr_b16 v[226:227], v253 offset:2048
v_mfma_f32_16x16x32_bf16 v[204:207], v[228:231], v[92:95], v[204:207]
s_waitcnt lgkmcnt(10)
ds_read_b64_tr_b16 v[228:229], v253 offset:8192
v_mfma_f32_16x16x32_bf16 v[196:199], v[232:235], v[96:99], v[196:199]
s_cselect_b32 s44, s43, 0x7ff00000
ds_read_b64_tr_b16 v[230:231], v253 offset:10240
v_mfma_f32_16x16x32_bf16 v[204:207], v[232:235], v[100:103], v[204:207]
s_waitcnt lgkmcnt(8)
ds_read_b64_tr_b16 v[232:233], v253 offset:16384
v_mfma_f32_16x16x32_bf16 v[196:199], v[236:239], v[104:107], v[196:199]
ds_read_b64_tr_b16 v[234:235], v253 offset:18432
v_mfma_f32_16x16x32_bf16 v[204:207], v[236:239], v[108:111], v[204:207]
s_waitcnt lgkmcnt(8)
ds_read_b64_tr_b16 v[236:237], v253 offset:24576
v_mfma_f32_16x16x32_bf16 v[196:199], v[240:243], v[112:115], v[196:199]
s_barrier
ds_read_b64_tr_b16 v[238:239], v253 offset:26624
v_xor_b32 v253, 36864, v253
v_mfma_f32_16x16x32_bf16 v[204:207], v[240:243], v[116:119], v[204:207]
s_waitcnt lgkmcnt(8)
ds_read_b64_tr_b16 v[240:241], v253 offset:0
v_mfma_f32_16x16x32_bf16 v[196:199], v[244:247], v[120:123], v[196:199]
s_add_u32 s47, s42, s44
s_add_u32 s42, s42, 0x4000
ds_read_b64_tr_b16 v[242:243], v253 offset:2048
v_mfma_f32_16x16x32_bf16 v[204:207], v[244:247], v[124:127], v[204:207]
s_waitcnt lgkmcnt(8)
ds_read_b64_tr_b16 v[244:245], v253 offset:8192
v_mfma_f32_16x16x32_bf16 v[192:195], v[224:227], v[96:99], v[192:195]
s_sub_u32 s43, s43, 0x400
s_and_b32 s43, s43, 0x3c00
ds_read_b64_tr_b16 v[246:247], v253 offset:10240
v_mfma_f32_16x16x32_bf16 v[200:203], v[224:227], v[100:103], v[200:203]
s_waitcnt lgkmcnt(8)
ds_read_b64_tr_b16 v[224:225], v253 offset:16384
v_mfma_f32_16x16x32_bf16 v[192:195], v[228:231], v[104:107], v[192:195]
s_cselect_b32 s44, s43, 0x7ff00000
s_add_u32 s48, s42, s44
ds_read_b64_tr_b16 v[226:227], v253 offset:18432
v_mfma_f32_16x16x32_bf16 v[200:203], v[228:231], v[108:111], v[200:203]
s_waitcnt lgkmcnt(8)
ds_read_b64_tr_b16 v[228:229], v253 offset:24576
v_mfma_f32_16x16x32_bf16 v[192:195], v[232:235], v[112:115], v[192:195]
s_add_u32 s46, s46, 2
ds_read_b64_tr_b16 v[230:231], v253 offset:26624
v_xor_b32 v253, 32, v253
v_mfma_f32_16x16x32_bf16 v[200:203], v[232:235], v[116:119], v[200:203]
s_waitcnt lgkmcnt(8)
ds_read_b64_tr_b16 v[232:233], v253 offset:0
v_mfma_f32_16x16x32_bf16 v[192:195], v[236:239], v[120:123], v[192:195]
s_cmp_ge_u32 s46, 14
s_cselect_b32 s46, 0, s46
ds_read_b64_tr_b16 v[234:235], v253 offset:2048
v_mfma_f32_16x16x32_bf16 v[200:203], v[236:239], v[124:127], v[200:203]
s_waitcnt lgkmcnt(8)
ds_read_b64_tr_b16 v[236:237], v253 offset:8192
v_mfma_f32_16x16x32_bf16 v[208:211], v[240:243], v[64:67], 0
ds_read_b64_tr_b16 v[238:239], v253 offset:10240
v_mfma_f32_16x16x32_bf16 v[216:219], v[240:243], v[68:71], 0
s_waitcnt lgkmcnt(8)
ds_read_b64_tr_b16 v[240:241], v253 offset:16384
v_mfma_f32_16x16x32_bf16 v[208:211], v[244:247], v[72:75], v[208:211]
ds_read_b64_tr_b16 v[242:243], v253 offset:18432
v_mfma_f32_16x16x32_bf16 v[216:219], v[244:247], v[76:79], v[216:219]
s_waitcnt lgkmcnt(8)
ds_read_b64_tr_b16 v[244:245], v253 offset:24576
v_cvt_pk_bf16_f32 v128, v192, v193
v_mfma_f32_16x16x32_bf16 v[208:211], v[224:227], v[80:83], v[208:211]
ds_read_b64_tr_b16 v[246:247], v253 offset:26624
v_xor_b32 v253, 4096, v253
v_mfma_f32_16x16x32_bf16 v[216:219], v[224:227], v[84:87], v[216:219]
s_waitcnt lgkmcnt(8)
ds_read_b64_tr_b16 v[224:225], v253 offset:0
v_cvt_pk_bf16_f32 v129, v194, v195
v_mfma_f32_16x16x32_bf16 v[208:211], v[228:231], v[88:91], v[208:211]
s_lshl_b32 s42, s46, 16
ds_read_b64_tr_b16 v[226:227], v253 offset:2048
v_cvt_pk_bf16_f32 v130, v196, v197
v_mfma_f32_16x16x32_bf16 v[216:219], v[228:231], v[92:95], v[216:219]
s_waitcnt lgkmcnt(8)
ds_read_b64_tr_b16 v[228:229], v253 offset:8192
v_cvt_pk_bf16_f32 v131, v198, v199
v_mfma_f32_16x16x32_bf16 v[212:215], v[232:235], v[64:67], 0
s_add_u32 s42, s42, s45
ds_read_b64_tr_b16 v[230:231], v253 offset:10240
buffer_store_dwordx4 v[128:131], v252, s[32:35], s47 offen sc1
v_mfma_f32_16x16x32_bf16 v[220:223], v[232:235], v[68:71], 0
s_waitcnt lgkmcnt(8)
ds_read_b64_tr_b16 v[232:233], v253 offset:16384
v_cvt_pk_bf16_f32 v132, v200, v201
v_mfma_f32_16x16x32_bf16 v[212:215], v[236:239], v[72:75], v[212:215]
s_sub_u32 s43, s89, s46
ds_read_b64_tr_b16 v[234:235], v253 offset:18432
v_cvt_pk_bf16_f32 v133, v202, v203
v_mfma_f32_16x16x32_bf16 v[220:223], v[236:239], v[76:79], v[220:223]
s_waitcnt lgkmcnt(8)
ds_read_b64_tr_b16 v[236:237], v253 offset:24576
v_cvt_pk_bf16_f32 v134, v204, v205
v_mfma_f32_16x16x32_bf16 v[212:215], v[240:243], v[80:83], v[212:215]
s_and_b32 s43, s43, 15
ds_read_b64_tr_b16 v[238:239], v253 offset:26624
v_xor_b32 v253, 32, v253
v_mfma_f32_16x16x32_bf16 v[220:223], v[240:243], v[84:87], v[220:223]
s_waitcnt lgkmcnt(8)
ds_read_b64_tr_b16 v[240:241], v253 offset:0
v_cvt_pk_bf16_f32 v135, v206, v207
v_mfma_f32_16x16x32_bf16 v[212:215], v[244:247], v[88:91], v[212:215]
s_lshl_b32 s43, s43, 10
ds_read_b64_tr_b16 v[242:243], v253 offset:2048
buffer_store_dwordx4 v[132:135], v252, s[32:35], s48 offen sc1
v_mfma_f32_16x16x32_bf16 v[220:223], v[244:247], v[92:95], v[220:223]
s_waitcnt lgkmcnt(8)
ds_read_b64_tr_b16 v[244:245], v253 offset:8192
v_mfma_f32_16x16x32_bf16 v[212:215], v[224:227], v[96:99], v[212:215]
s_cselect_b32 s44, s43, 0x7ff00000
ds_read_b64_tr_b16 v[246:247], v253 offset:10240
v_mfma_f32_16x16x32_bf16 v[220:223], v[224:227], v[100:103], v[220:223]
s_waitcnt lgkmcnt(8)
ds_read_b64_tr_b16 v[224:225], v253 offset:16384
v_mfma_f32_16x16x32_bf16 v[212:215], v[228:231], v[104:107], v[212:215]
ds_read_b64_tr_b16 v[226:227], v253 offset:18432
v_mfma_f32_16x16x32_bf16 v[220:223], v[228:231], v[108:111], v[220:223]
s_waitcnt lgkmcnt(8)
ds_read_b64_tr_b16 v[228:229], v253 offset:24576
v_mfma_f32_16x16x32_bf16 v[212:215], v[232:235], v[112:115], v[212:215]
s_barrier
ds_read_b64_tr_b16 v[230:231], v253 offset:26624
v_xor_b32 v253, 233472, v253
v_mfma_f32_16x16x32_bf16 v[220:223], v[232:235], v[116:119], v[220:223]
s_waitcnt lgkmcnt(8)
ds_read_b64_tr_b16 v[232:233], v253 offset:0
v_mfma_f32_16x16x32_bf16 v[212:215], v[236:239], v[120:123], v[212:215]
s_add_u32 s47, s42, s44
s_add_u32 s42, s42, 0x4000
ds_read_b64_tr_b16 v[234:235], v253 offset:2048
v_mfma_f32_16x16x32_bf16 v[220:223], v[236:239], v[124:127], v[220:223]
s_waitcnt lgkmcnt(8)
ds_read_b64_tr_b16 v[236:237], v253 offset:8192
v_mfma_f32_16x16x32_bf16 v[208:211], v[240:243], v[96:99], v[208:211]
s_sub_u32 s43, s43, 0x400
s_and_b32 s43, s43, 0x3c00
ds_read_b64_tr_b16 v[238:239], v253 offset:10240
v_mfma_f32_16x16x32_bf16 v[216:219], v[240:243], v[100:103], v[216:219]
s_waitcnt lgkmcnt(8)
ds_read_b64_tr_b16 v[240:241], v253 offset:16384
v_mfma_f32_16x16x32_bf16 v[208:211], v[244:247], v[104:107], v[208:211]
s_cselect_b32 s44, s43, 0x7ff00000
s_add_u32 s48, s42, s44
ds_read_b64_tr_b16 v[242:243], v253 offset:18432
v_mfma_f32_16x16x32_bf16 v[216:219], v[244:247], v[108:111], v[216:219]
s_waitcnt lgkmcnt(8)
ds_read_b64_tr_b16 v[244:245], v253 offset:24576
v_mfma_f32_16x16x32_bf16 v[208:211], v[224:227], v[112:115], v[208:211]
s_add_u32 s46, s46, 2
ds_read_b64_tr_b16 v[246:247], v253 offset:26624
v_xor_b32 v253, 32, v253
v_mfma_f32_16x16x32_bf16 v[216:219], v[224:227], v[116:119], v[216:219]
s_waitcnt lgkmcnt(8)
ds_read_b64_tr_b16 v[224:225], v253 offset:0
v_mfma_f32_16x16x32_bf16 v[208:211], v[228:231], v[120:123], v[208:211]
s_cmp_ge_u32 s46, 14
s_cselect_b32 s46, 0, s46
ds_read_b64_tr_b16 v[226:227], v253 offset:2048
v_mfma_f32_16x16x32_bf16 v[216:219], v[228:231], v[124:127], v[216:219]
s_waitcnt lgkmcnt(8)
ds_read_b64_tr_b16 v[228:229], v253 offset:8192
v_mfma_f32_16x16x32_bf16 v[192:195], v[232:235], v[64:67], 0
ds_read_b64_tr_b16 v[230:231], v253 offset:10240
v_mfma_f32_16x16x32_bf16 v[200:203], v[232:235], v[68:71], 0
s_waitcnt lgkmcnt(8)
ds_read_b64_tr_b16 v[232:233], v253 offset:16384
v_mfma_f32_16x16x32_bf16 v[192:195], v[236:239], v[72:75], v[192:195]
ds_read_b64_tr_b16 v[234:235], v253 offset:18432
v_mfma_f32_16x16x32_bf16 v[200:203], v[236:239], v[76:79], v[200:203]
s_waitcnt lgkmcnt(8)
ds_read_b64_tr_b16 v[236:237], v253 offset:24576
v_cvt_pk_bf16_f32 v136, v208, v209
v_mfma_f32_16x16x32_bf16 v[192:195], v[240:243], v[80:83], v[192:195]
ds_read_b64_tr_b16 v[238:239], v253 offset:26624
v_xor_b32 v253, 4096, v253
v_mfma_f32_16x16x32_bf16 v[200:203], v[240:243], v[84:87], v[200:203]
s_waitcnt lgkmcnt(8)
ds_read_b64_tr_b16 v[240:241], v253 offset:0
v_cvt_pk_bf16_f32 v137, v210, v211
v_mfma_f32_16x16x32_bf16 v[192:195], v[244:247], v[88:91], v[192:195]
s_lshl_b32 s42, s46, 16
ds_read_b64_tr_b16 v[242:243], v253 offset:2048
v_cvt_pk_bf16_f32 v138, v212, v213
v_mfma_f32_16x16x32_bf16 v[200:203], v[244:247], v[92:95], v[200:203]
s_waitcnt lgkmcnt(8)
ds_read_b64_tr_b16 v[244:245], v253 offset:8192
v_cvt_pk_bf16_f32 v139, v214, v215
v_mfma_f32_16x16x32_bf16 v[196:199], v[224:227], v[64:67], 0
s_add_u32 s42, s42, s45
ds_read_b64_tr_b16 v[246:247], v253 offset:10240
buffer_store_dwordx4 v[136:139], v252, s[32:35], s47 offen sc1
v_mfma_f32_16x16x32_bf16 v[204:207], v[224:227], v[68:71], 0
s_waitcnt lgkmcnt(8)
ds_read_b64_tr_b16 v[224:225], v253 offset:16384
v_cvt_pk_bf16_f32 v140, v216, v217
v_mfma_f32_16x16x32_bf16 v[196:199], v[228:231], v[72:75], v[196:199]
s_sub_u32 s43, s89, s46
ds_read_b64_tr_b16 v[226:227], v253 offset:18432
v_cvt_pk_bf16_f32 v141, v218, v219
v_mfma_f32_16x16x32_bf16 v[204:207], v[228:231], v[76:79], v[204:207]
s_waitcnt lgkmcnt(8)
ds_read_b64_tr_b16 v[228:229], v253 offset:24576
v_cvt_pk_bf16_f32 v142, v220, v221
v_mfma_f32_16x16x32_bf16 v[196:199], v[232:235], v[80:83], v[196:199]
s_and_b32 s43, s43, 15
ds_read_b64_tr_b16 v[230:231], v253 offset:26624
v_xor_b32 v253, 32, v253
v_mfma_f32_16x16x32_bf16 v[204:207], v[232:235], v[84:87], v[204:207]
s_waitcnt lgkmcnt(8)
ds_read_b64_tr_b16 v[232:233], v253 offset:0
v_cvt_pk_bf16_f32 v143, v222, v223
v_mfma_f32_16x16x32_bf16 v[196:199], v[236:239], v[88:91], v[196:199]
s_lshl_b32 s43, s43, 10
ds_read_b64_tr_b16 v[234:235], v253 offset:2048
buffer_store_dwordx4 v[140:143], v252, s[32:35], s48 offen sc1
v_mfma_f32_16x16x32_bf16 v[204:207], v[236:239], v[92:95], v[204:207]
s_waitcnt lgkmcnt(8)
ds_read_b64_tr_b16 v[236:237], v253 offset:8192
v_mfma_f32_16x16x32_bf16 v[196:199], v[240:243], v[96:99], v[196:199]
s_cselect_b32 s44, s43, 0x7ff00000
ds_read_b64_tr_b16 v[238:239], v253 offset:10240
v_mfma_f32_16x16x32_bf16 v[204:207], v[240:243], v[100:103], v[204:207]
s_waitcnt lgkmcnt(8)
ds_read_b64_tr_b16 v[240:241], v253 offset:16384
v_mfma_f32_16x16x32_bf16 v[196:199], v[244:247], v[104:107], v[196:199]
ds_read_b64_tr_b16 v[242:243], v253 offset:18432
v_mfma_f32_16x16x32_bf16 v[204:207], v[244:247], v[108:111], v[204:207]
s_waitcnt lgkmcnt(8)
ds_read_b64_tr_b16 v[244:245], v253 offset:24576
v_mfma_f32_16x16x32_bf16 v[196:199], v[224:227], v[112:115], v[196:199]
s_barrier
ds_read_b64_tr_b16 v[246:247], v253 offset:26624
v_xor_b32 v253, 167936, v253
v_mfma_f32_16x16x32_bf16 v[204:207], v[224:227], v[116:119], v[204:207]
s_waitcnt lgkmcnt(8)
ds_read_b64_tr_b16 v[224:225], v253 offset:0
v_mfma_f32_16x16x32_bf16 v[196:199], v[228:231], v[120:123], v[196:199]
s_add_u32 s47, s42, s44
s_add_u32 s42, s42, 0x4000
ds_read_b64_tr_b16 v[226:227], v253 offset:2048
v_mfma_f32_16x16x32_bf16 v[204:207], v[228:231], v[124:127], v[204:207]
s_waitcnt lgkmcnt(8)
ds_read_b64_tr_b16 v[228:229], v253 offset:8192
v_mfma_f32_16x16x32_bf16 v[192:195], v[232:235], v[96:99], v[192:195]
s_sub_u32 s43, s43, 0x400
s_and_b32 s43, s43, 0x3c00
ds_read_b64_tr_b16 v[230:231], v253 offset:10240
v_mfma_f32_16x16x32_bf16 v[200:203], v[232:235], v[100:103], v[200:203]
s_waitcnt lgkmcnt(8)
ds_read_b64_tr_b16 v[232:233], v253 offset:16384
v_mfma_f32_16x16x32_bf16 v[192:195], v[236:239], v[104:107], v[192:195]
s_cselect_b32 s44, s43, 0x7ff00000
s_add_u32 s48, s42, s44
ds_read_b64_tr_b16 v[234:235], v253 offset:18432
v_mfma_f32_16x16x32_bf16 v[200:203], v[236:239], v[108:111], v[200:203]
s_waitcnt lgkmcnt(8)
ds_read_b64_tr_b16 v[236:237], v253 offset:24576
v_mfma_f32_16x16x32_bf16 v[192:195], v[240:243], v[112:115], v[192:195]
s_add_u32 s46, s46, 2
ds_read_b64_tr_b16 v[238:239], v253 offset:26624
v_xor_b32 v253, 32, v253
v_mfma_f32_16x16x32_bf16 v[200:203], v[240:243], v[116:119], v[200:203]
s_waitcnt lgkmcnt(8)
ds_read_b64_tr_b16 v[240:241], v253 offset:0
v_mfma_f32_16x16x32_bf16 v[192:195], v[244:247], v[120:123], v[192:195]
s_cmp_ge_u32 s46, 14
s_cselect_b32 s46, 0, s46
ds_read_b64_tr_b16 v[242:243], v253 offset:2048
v_mfma_f32_16x16x32_bf16 v[200:203], v[244:247], v[124:127], v[200:203]
s_waitcnt lgkmcnt(8)
ds_read_b64_tr_b16 v[244:245], v253 offset:8192
v_mfma_f32_16x16x32_bf16 v[208:211], v[224:227], v[64:67], 0
ds_read_b64_tr_b16 v[246:247], v253 offset:10240
v_mfma_f32_16x16x32_bf16 v[216:219], v[224:227], v[68:71], 0
s_waitcnt lgkmcnt(8)
ds_read_b64_tr_b16 v[224:225], v253 offset:16384
v_mfma_f32_16x16x32_bf16 v[208:211], v[228:231], v[72:75], v[208:211]
ds_read_b64_tr_b16 v[226:227], v253 offset:18432
v_mfma_f32_16x16x32_bf16 v[216:219], v[228:231], v[76:79], v[216:219]
s_waitcnt lgkmcnt(8)
ds_read_b64_tr_b16 v[228:229], v253 offset:24576
v_cvt_pk_bf16_f32 v144, v192, v193
v_mfma_f32_16x16x32_bf16 v[208:211], v[232:235], v[80:83], v[208:211]
ds_read_b64_tr_b16 v[230:231], v253 offset:26624
v_xor_b32 v253, 4096, v253
v_mfma_f32_16x16x32_bf16 v[216:219], v[232:235], v[84:87], v[216:219]
s_waitcnt lgkmcnt(8)
ds_read_b64_tr_b16 v[232:233], v253 offset:0
v_cvt_pk_bf16_f32 v145, v194, v195
v_mfma_f32_16x16x32_bf16 v[208:211], v[236:239], v[88:91], v[208:211]
s_lshl_b32 s42, s46, 16
ds_read_b64_tr_b16 v[234:235], v253 offset:2048
v_cvt_pk_bf16_f32 v146, v196, v197
v_mfma_f32_16x16x32_bf16 v[216:219], v[236:239], v[92:95], v[216:219]
s_waitcnt lgkmcnt(8)
ds_read_b64_tr_b16 v[236:237], v253 offset:8192
v_cvt_pk_bf16_f32 v147, v198, v199
v_mfma_f32_16x16x32_bf16 v[212:215], v[240:243], v[64:67], 0
s_add_u32 s42, s42, s45
ds_read_b64_tr_b16 v[238:239], v253 offset:10240
buffer_store_dwordx4 v[144:147], v252, s[32:35], s47 offen sc1
v_mfma_f32_16x16x32_bf16 v[220:223], v[240:243], v[68:71], 0
s_waitcnt lgkmcnt(8)
ds_read_b64_tr_b16 v[240:241], v253 offset:16384
v_cvt_pk_bf16_f32 v148, v200, v201
v_mfma_f32_16x16x32_bf16 v[212:215], v[244:247], v[72:75], v[212:215]
s_sub_u32 s43, s89, s46
ds_read_b64_tr_b16 v[242:243], v253 offset:18432
v_cvt_pk_bf16_f32 v149, v202, v203
v_mfma_f32_16x16x32_bf16 v[220:223], v[244:247], v[76:79], v[220:223]
s_waitcnt lgkmcnt(8)
ds_read_b64_tr_b16 v[244:245], v253 offset:24576
v_cvt_pk_bf16_f32 v150, v204, v205
v_mfma_f32_16x16x32_bf16 v[212:215], v[224:227], v[80:83], v[212:215]
s_and_b32 s43, s43, 15
ds_read_b64_tr_b16 v[246:247], v253 offset:26624
v_xor_b32 v253, 32, v253
v_mfma_f32_16x16x32_bf16 v[220:223], v[224:227], v[84:87], v[220:223]
s_waitcnt lgkmcnt(8)
ds_read_b64_tr_b16 v[224:225], v253 offset:0
v_cvt_pk_bf16_f32 v151, v206, v207
v_mfma_f32_16x16x32_bf16 v[212:215], v[228:231], v[88:91], v[212:215]
s_lshl_b32 s43, s43, 10
ds_read_b64_tr_b16 v[226:227], v253 offset:2048
buffer_store_dwordx4 v[148:151], v252, s[32:35], s48 offen sc1
v_mfma_f32_16x16x32_bf16 v[220:223], v[228:231], v[92:95], v[220:223]
s_waitcnt lgkmcnt(8)
ds_read_b64_tr_b16 v[228:229], v253 offset:8192
v_mfma_f32_16x16x32_bf16 v[212:215], v[232:235], v[96:99], v[212:215]
s_cselect_b32 s44, s43, 0x7ff00000
ds_read_b64_tr_b16 v[230:231], v253 offset:10240
v_mfma_f32_16x16x32_bf16 v[220:223], v[232:235], v[100:103], v[220:223]
s_waitcnt lgkmcnt(8)
ds_read_b64_tr_b16 v[232:233], v253 offset:16384
v_mfma_f32_16x16x32_bf16 v[212:215], v[236:239], v[104:107], v[212:215]
ds_read_b64_tr_b16 v[234:235], v253 offset:18432
v_mfma_f32_16x16x32_bf16 v[220:223], v[236:239], v[108:111], v[220:223]
s_waitcnt lgkmcnt(8)
ds_read_b64_tr_b16 v[236:237], v253 offset:24576
v_mfma_f32_16x16x32_bf16 v[212:215], v[240:243], v[112:115], v[212:215]
s_barrier
ds_read_b64_tr_b16 v[238:239], v253 offset:26624
v_xor_b32 v253, 36864, v253
v_mfma_f32_16x16x32_bf16 v[220:223], v[240:243], v[116:119], v[220:223]
s_waitcnt lgkmcnt(8)
ds_read_b64_tr_b16 v[240:241], v253 offset:0
v_mfma_f32_16x16x32_bf16 v[212:215], v[244:247], v[120:123], v[212:215]
s_add_u32 s47, s42, s44
s_add_u32 s42, s42, 0x4000
ds_read_b64_tr_b16 v[242:243], v253 offset:2048
v_mfma_f32_16x16x32_bf16 v[220:223], v[244:247], v[124:127], v[220:223]
s_waitcnt lgkmcnt(8)
ds_read_b64_tr_b16 v[244:245], v253 offset:8192
v_mfma_f32_16x16x32_bf16 v[208:211], v[224:227], v[96:99], v[208:211]
s_sub_u32 s43, s43, 0x400
s_and_b32 s43, s43, 0x3c00
ds_read_b64_tr_b16 v[246:247], v253 offset:10240
v_mfma_f32_16x16x32_bf16 v[216:219], v[224:227], v[100:103], v[216:219]
s_waitcnt lgkmcnt(8)
ds_read_b64_tr_b16 v[224:225], v253 offset:16384
v_mfma_f32_16x16x32_bf16 v[208:211], v[228:231], v[104:107], v[208:211]
s_cselect_b32 s44, s43, 0x7ff00000
s_add_u32 s48, s42, s44
ds_read_b64_tr_b16 v[226:227], v253 offset:18432
v_mfma_f32_16x16x32_bf16 v[216:219], v[228:231], v[108:111], v[216:219]
s_waitcnt lgkmcnt(8)
ds_read_b64_tr_b16 v[228:229], v253 offset:24576
v_mfma_f32_16x16x32_bf16 v[208:211], v[232:235], v[112:115], v[208:211]
s_add_u32 s46, s46, 2
ds_read_b64_tr_b16 v[230:231], v253 offset:26624
v_xor_b32 v253, 32, v253
v_mfma_f32_16x16x32_bf16 v[216:219], v[232:235], v[116:119], v[216:219]
s_waitcnt lgkmcnt(8)
ds_read_b64_tr_b16 v[232:233], v253 offset:0
v_mfma_f32_16x16x32_bf16 v[208:211], v[236:239], v[120:123], v[208:211]
s_cmp_ge_u32 s46, 14
s_cselect_b32 s46, 0, s46
ds_read_b64_tr_b16 v[234:235], v253 offset:2048
v_mfma_f32_16x16x32_bf16 v[216:219], v[236:239], v[124:127], v[216:219]
s_waitcnt lgkmcnt(8)
ds_read_b64_tr_b16 v[236:237], v253 offset:8192
v_mfma_f32_16x16x32_bf16 v[192:195], v[240:243], v[64:67], 0
ds_read_b64_tr_b16 v[238:239], v253 offset:10240
v_mfma_f32_16x16x32_bf16 v[200:203], v[240:243], v[68:71], 0
s_waitcnt lgkmcnt(8)
ds_read_b64_tr_b16 v[240:241], v253 offset:16384
v_mfma_f32_16x16x32_bf16 v[192:195], v[244:247], v[72:75], v[192:195]
ds_read_b64_tr_b16 v[242:243], v253 offset:18432
v_mfma_f32_16x16x32_bf16 v[200:203], v[244:247], v[76:79], v[200:203]
s_waitcnt lgkmcnt(8)
ds_read_b64_tr_b16 v[244:245], v253 offset:24576
v_cvt_pk_bf16_f32 v152, v208, v209
v_mfma_f32_16x16x32_bf16 v[192:195], v[224:227], v[80:83], v[192:195]
ds_read_b64_tr_b16 v[246:247], v253 offset:26624
v_xor_b32 v253, 4096, v253
v_mfma_f32_16x16x32_bf16 v[200:203], v[224:227], v[84:87], v[200:203]
s_waitcnt lgkmcnt(8)
ds_read_b64_tr_b16 v[224:225], v253 offset:0
v_cvt_pk_bf16_f32 v153, v210, v211
v_mfma_f32_16x16x32_bf16 v[192:195], v[228:231], v[88:91], v[192:195]
s_lshl_b32 s42, s46, 16
ds_read_b64_tr_b16 v[226:227], v253 offset:2048
v_cvt_pk_bf16_f32 v154, v212, v213
v_mfma_f32_16x16x32_bf16 v[200:203], v[228:231], v[92:95], v[200:203]
s_waitcnt lgkmcnt(8)
ds_read_b64_tr_b16 v[228:229], v253 offset:8192
v_cvt_pk_bf16_f32 v155, v214, v215
v_mfma_f32_16x16x32_bf16 v[196:199], v[232:235], v[64:67], 0
s_add_u32 s42, s42, s45
ds_read_b64_tr_b16 v[230:231], v253 offset:10240
buffer_store_dwordx4 v[152:155], v252, s[32:35], s47 offen sc1
v_mfma_f32_16x16x32_bf16 v[204:207], v[232:235], v[68:71], 0
s_waitcnt lgkmcnt(8)
ds_read_b64_tr_b16 v[232:233], v253 offset:16384
v_cvt_pk_bf16_f32 v156, v216, v217
v_mfma_f32_16x16x32_bf16 v[196:199], v[236:239], v[72:75], v[196:199]
s_sub_u32 s43, s89, s46
ds_read_b64_tr_b16 v[234:235], v253 offset:18432
v_cvt_pk_bf16_f32 v157, v218, v219
v_mfma_f32_16x16x32_bf16 v[204:207], v[236:239], v[76:79], v[204:207]
s_waitcnt lgkmcnt(8)
ds_read_b64_tr_b16 v[236:237], v253 offset:24576
v_cvt_pk_bf16_f32 v158, v220, v221
v_mfma_f32_16x16x32_bf16 v[196:199], v[240:243], v[80:83], v[196:199]
s_and_b32 s43, s43, 15
ds_read_b64_tr_b16 v[238:239], v253 offset:26624
v_xor_b32 v253, 32, v253
v_mfma_f32_16x16x32_bf16 v[204:207], v[240:243], v[84:87], v[204:207]
s_waitcnt lgkmcnt(8)
ds_read_b64_tr_b16 v[240:241], v253 offset:0
v_cvt_pk_bf16_f32 v159, v222, v223
v_mfma_f32_16x16x32_bf16 v[196:199], v[244:247], v[88:91], v[196:199]
s_lshl_b32 s43, s43, 10
ds_read_b64_tr_b16 v[242:243], v253 offset:2048
buffer_store_dwordx4 v[156:159], v252, s[32:35], s48 offen sc1
v_mfma_f32_16x16x32_bf16 v[204:207], v[244:247], v[92:95], v[204:207]
s_waitcnt lgkmcnt(8)
ds_read_b64_tr_b16 v[244:245], v253 offset:8192
v_mfma_f32_16x16x32_bf16 v[196:199], v[224:227], v[96:99], v[196:199]
s_cselect_b32 s44, s43, 0x7ff00000
ds_read_b64_tr_b16 v[246:247], v253 offset:10240
v_mfma_f32_16x16x32_bf16 v[204:207], v[224:227], v[100:103], v[204:207]
s_waitcnt lgkmcnt(8)
ds_read_b64_tr_b16 v[224:225], v253 offset:16384
v_mfma_f32_16x16x32_bf16 v[196:199], v[228:231], v[104:107], v[196:199]
ds_read_b64_tr_b16 v[226:227], v253 offset:18432
v_mfma_f32_16x16x32_bf16 v[204:207], v[228:231], v[108:111], v[204:207]
s_waitcnt lgkmcnt(8)
ds_read_b64_tr_b16 v[228:229], v253 offset:24576
v_mfma_f32_16x16x32_bf16 v[196:199], v[232:235], v[112:115], v[196:199]
s_barrier
ds_read_b64_tr_b16 v[230:231], v253 offset:26624
v_xor_b32 v253, 69632, v253
v_mfma_f32_16x16x32_bf16 v[204:207], v[232:235], v[116:119], v[204:207]
s_waitcnt lgkmcnt(8)
ds_read_b64_tr_b16 v[232:233], v253 offset:0
v_mfma_f32_16x16x32_bf16 v[196:199], v[236:239], v[120:123], v[196:199]
s_add_u32 s47, s42, s44
s_add_u32 s42, s42, 0x4000
ds_read_b64_tr_b16 v[234:235], v253 offset:2048
v_mfma_f32_16x16x32_bf16 v[204:207], v[236:239], v[124:127], v[204:207]
s_waitcnt lgkmcnt(8)
ds_read_b64_tr_b16 v[236:237], v253 offset:8192
v_mfma_f32_16x16x32_bf16 v[192:195], v[240:243], v[96:99], v[192:195]
s_sub_u32 s43, s43, 0x400
s_and_b32 s43, s43, 0x3c00
ds_read_b64_tr_b16 v[238:239], v253 offset:10240
v_mfma_f32_16x16x32_bf16 v[200:203], v[240:243], v[100:103], v[200:203]
s_waitcnt lgkmcnt(8)
ds_read_b64_tr_b16 v[240:241], v253 offset:16384
v_mfma_f32_16x16x32_bf16 v[192:195], v[244:247], v[104:107], v[192:195]
s_cselect_b32 s44, s43, 0x7ff00000
s_add_u32 s48, s42, s44
ds_read_b64_tr_b16 v[242:243], v253 offset:18432
v_mfma_f32_16x16x32_bf16 v[200:203], v[244:247], v[108:111], v[200:203]
s_waitcnt lgkmcnt(8)
ds_read_b64_tr_b16 v[244:245], v253 offset:24576
v_mfma_f32_16x16x32_bf16 v[192:195], v[224:227], v[112:115], v[192:195]
s_add_u32 s46, s46, 2
ds_read_b64_tr_b16 v[246:247], v253 offset:26624
v_xor_b32 v253, 32, v253
v_mfma_f32_16x16x32_bf16 v[200:203], v[224:227], v[116:119], v[200:203]
s_waitcnt lgkmcnt(8)
ds_read_b64_tr_b16 v[224:225], v253 offset:0
v_mfma_f32_16x16x32_bf16 v[192:195], v[228:231], v[120:123], v[192:195]
s_cmp_ge_u32 s46, 14
s_cselect_b32 s46, 0, s46
ds_read_b64_tr_b16 v[226:227], v253 offset:2048
v_mfma_f32_16x16x32_bf16 v[200:203], v[228:231], v[124:127], v[200:203]
s_waitcnt lgkmcnt(8)
ds_read_b64_tr_b16 v[228:229], v253 offset:8192
v_mfma_f32_16x16x32_bf16 v[208:211], v[232:235], v[64:67], 0
ds_read_b64_tr_b16 v[230:231], v253 offset:10240
v_mfma_f32_16x16x32_bf16 v[216:219], v[232:235], v[68:71], 0
s_waitcnt lgkmcnt(8)
ds_read_b64_tr_b16 v[232:233], v253 offset:16384
v_mfma_f32_16x16x32_bf16 v[208:211], v[236:239], v[72:75], v[208:211]
ds_read_b64_tr_b16 v[234:235], v253 offset:18432
v_mfma_f32_16x16x32_bf16 v[216:219], v[236:239], v[76:79], v[216:219]
s_waitcnt lgkmcnt(8)
ds_read_b64_tr_b16 v[236:237], v253 offset:24576
v_cvt_pk_bf16_f32 v160, v192, v193
v_mfma_f32_16x16x32_bf16 v[208:211], v[240:243], v[80:83], v[208:211]
ds_read_b64_tr_b16 v[238:239], v253 offset:26624
v_xor_b32 v253, 4096, v253
v_mfma_f32_16x16x32_bf16 v[216:219], v[240:243], v[84:87], v[216:219]
s_waitcnt lgkmcnt(8)
ds_read_b64_tr_b16 v[240:241], v253 offset:0
v_cvt_pk_bf16_f32 v161, v194, v195
v_mfma_f32_16x16x32_bf16 v[208:211], v[244:247], v[88:91], v[208:211]
s_lshl_b32 s42, s46, 16
ds_read_b64_tr_b16 v[242:243], v253 offset:2048
v_cvt_pk_bf16_f32 v162, v196, v197
v_mfma_f32_16x16x32_bf16 v[216:219], v[244:247], v[92:95], v[216:219]
s_waitcnt lgkmcnt(8)
ds_read_b64_tr_b16 v[244:245], v253 offset:8192
v_cvt_pk_bf16_f32 v163, v198, v199
v_mfma_f32_16x16x32_bf16 v[212:215], v[224:227], v[64:67], 0
s_add_u32 s42, s42, s45
ds_read_b64_tr_b16 v[246:247], v253 offset:10240
buffer_store_dwordx4 v[160:163], v252, s[32:35], s47 offen sc1
v_mfma_f32_16x16x32_bf16 v[220:223], v[224:227], v[68:71], 0
s_waitcnt lgkmcnt(8)
ds_read_b64_tr_b16 v[224:225], v253 offset:16384
v_cvt_pk_bf16_f32 v164, v200, v201
v_mfma_f32_16x16x32_bf16 v[212:215], v[228:231], v[72:75], v[212:215]
s_sub_u32 s43, s89, s46
ds_read_b64_tr_b16 v[226:227], v253 offset:18432
v_cvt_pk_bf16_f32 v165, v202, v203
v_mfma_f32_16x16x32_bf16 v[220:223], v[228:231], v[76:79], v[220:223]
s_waitcnt lgkmcnt(8)
ds_read_b64_tr_b16 v[228:229], v253 offset:24576
v_cvt_pk_bf16_f32 v166, v204, v205
v_mfma_f32_16x16x32_bf16 v[212:215], v[232:235], v[80:83], v[212:215]
s_and_b32 s43, s43, 15
ds_read_b64_tr_b16 v[230:231], v253 offset:26624
v_xor_b32 v253, 32, v253
v_mfma_f32_16x16x32_bf16 v[220:223], v[232:235], v[84:87], v[220:223]
s_waitcnt lgkmcnt(8)
ds_read_b64_tr_b16 v[232:233], v253 offset:0
v_cvt_pk_bf16_f32 v167, v206, v207
v_mfma_f32_16x16x32_bf16 v[212:215], v[236:239], v[88:91], v[212:215]
s_lshl_b32 s43, s43, 10
ds_read_b64_tr_b16 v[234:235], v253 offset:2048
buffer_store_dwordx4 v[164:167], v252, s[32:35], s48 offen sc1
v_mfma_f32_16x16x32_bf16 v[220:223], v[236:239], v[92:95], v[220:223]
s_waitcnt lgkmcnt(8)
ds_read_b64_tr_b16 v[236:237], v253 offset:8192
v_mfma_f32_16x16x32_bf16 v[212:215], v[240:243], v[96:99], v[212:215]
s_cselect_b32 s44, s43, 0x7ff00000
ds_read_b64_tr_b16 v[238:239], v253 offset:10240
v_mfma_f32_16x16x32_bf16 v[220:223], v[240:243], v[100:103], v[220:223]
s_waitcnt lgkmcnt(8)
ds_read_b64_tr_b16 v[240:241], v253 offset:16384
v_mfma_f32_16x16x32_bf16 v[212:215], v[244:247], v[104:107], v[212:215]
ds_read_b64_tr_b16 v[242:243], v253 offset:18432
v_mfma_f32_16x16x32_bf16 v[220:223], v[244:247], v[108:111], v[220:223]
s_waitcnt lgkmcnt(8)
ds_read_b64_tr_b16 v[244:245], v253 offset:24576
v_mfma_f32_16x16x32_bf16 v[212:215], v[224:227], v[112:115], v[212:215]
s_barrier
ds_read_b64_tr_b16 v[246:247], v253 offset:26624
v_xor_b32 v253, 36864, v253
v_mfma_f32_16x16x32_bf16 v[220:223], v[224:227], v[116:119], v[220:223]
s_waitcnt lgkmcnt(8)
ds_read_b64_tr_b16 v[224:225], v253 offset:0
v_mfma_f32_16x16x32_bf16 v[212:215], v[228:231], v[120:123], v[212:215]
s_add_u32 s47, s42, s44
s_add_u32 s42, s42, 0x4000
ds_read_b64_tr_b16 v[226:227], v253 offset:2048
v_mfma_f32_16x16x32_bf16 v[220:223], v[228:231], v[124:127], v[220:223]
s_waitcnt lgkmcnt(8)
ds_read_b64_tr_b16 v[228:229], v253 offset:8192
v_mfma_f32_16x16x32_bf16 v[208:211], v[232:235], v[96:99], v[208:211]
s_sub_u32 s43, s43, 0x400
s_and_b32 s43, s43, 0x3c00
ds_read_b64_tr_b16 v[230:231], v253 offset:10240
v_mfma_f32_16x16x32_bf16 v[216:219], v[232:235], v[100:103], v[216:219]
s_waitcnt lgkmcnt(8)
ds_read_b64_tr_b16 v[232:233], v253 offset:16384
v_mfma_f32_16x16x32_bf16 v[208:211], v[236:239], v[104:107], v[208:211]
s_cselect_b32 s44, s43, 0x7ff00000
s_add_u32 s48, s42, s44
ds_read_b64_tr_b16 v[234:235], v253 offset:18432
v_mfma_f32_16x16x32_bf16 v[216:219], v[236:239], v[108:111], v[216:219]
s_waitcnt lgkmcnt(8)
ds_read_b64_tr_b16 v[236:237], v253 offset:24576
v_mfma_f32_16x16x32_bf16 v[208:211], v[240:243], v[112:115], v[208:211]
s_add_u32 s46, s46, 2
ds_read_b64_tr_b16 v[238:239], v253 offset:26624
v_xor_b32 v253, 32, v253
v_mfma_f32_16x16x32_bf16 v[216:219], v[240:243], v[116:119], v[216:219]
s_waitcnt lgkmcnt(8)
ds_read_b64_tr_b16 v[240:241], v253 offset:0
v_mfma_f32_16x16x32_bf16 v[208:211], v[244:247], v[120:123], v[208:211]
s_cmp_ge_u32 s46, 14
s_cselect_b32 s46, 0, s46
ds_read_b64_tr_b16 v[242:243], v253 offset:2048
v_mfma_f32_16x16x32_bf16 v[216:219], v[244:247], v[124:127], v[216:219]
s_waitcnt lgkmcnt(8)
ds_read_b64_tr_b16 v[244:245], v253 offset:8192
v_mfma_f32_16x16x32_bf16 v[192:195], v[224:227], v[64:67], 0
ds_read_b64_tr_b16 v[246:247], v253 offset:10240
v_mfma_f32_16x16x32_bf16 v[200:203], v[224:227], v[68:71], 0
s_waitcnt lgkmcnt(8)
ds_read_b64_tr_b16 v[224:225], v253 offset:16384
v_mfma_f32_16x16x32_bf16 v[192:195], v[228:231], v[72:75], v[192:195]
ds_read_b64_tr_b16 v[226:227], v253 offset:18432
v_mfma_f32_16x16x32_bf16 v[200:203], v[228:231], v[76:79], v[200:203]
s_waitcnt lgkmcnt(8)
ds_read_b64_tr_b16 v[228:229], v253 offset:24576
v_cvt_pk_bf16_f32 v168, v208, v209
v_mfma_f32_16x16x32_bf16 v[192:195], v[232:235], v[80:83], v[192:195]
ds_read_b64_tr_b16 v[230:231], v253 offset:26624
v_xor_b32 v253, 4096, v253
v_mfma_f32_16x16x32_bf16 v[200:203], v[232:235], v[84:87], v[200:203]
s_waitcnt lgkmcnt(8)
ds_read_b64_tr_b16 v[232:233], v253 offset:0
v_cvt_pk_bf16_f32 v169, v210, v211
v_mfma_f32_16x16x32_bf16 v[192:195], v[236:239], v[88:91], v[192:195]
s_lshl_b32 s42, s46, 16
ds_read_b64_tr_b16 v[234:235], v253 offset:2048
v_cvt_pk_bf16_f32 v170, v212, v213
v_mfma_f32_16x16x32_bf16 v[200:203], v[236:239], v[92:95], v[200:203]
s_waitcnt lgkmcnt(8)
ds_read_b64_tr_b16 v[236:237], v253 offset:8192
v_cvt_pk_bf16_f32 v171, v214, v215
v_mfma_f32_16x16x32_bf16 v[196:199], v[240:243], v[64:67], 0
s_add_u32 s42, s42, s45
ds_read_b64_tr_b16 v[238:239], v253 offset:10240
buffer_store_dwordx4 v[168:171], v252, s[32:35], s47 offen sc1
v_mfma_f32_16x16x32_bf16 v[204:207], v[240:243], v[68:71], 0
s_waitcnt lgkmcnt(8)
ds_read_b64_tr_b16 v[240:241], v253 offset:16384
v_cvt_pk_bf16_f32 v172, v216, v217
v_mfma_f32_16x16x32_bf16 v[196:199], v[244:247], v[72:75], v[196:199]
s_sub_u32 s43, s89, s46
ds_read_b64_tr_b16 v[242:243], v253 offset:18432
v_cvt_pk_bf16_f32 v173, v218, v219
v_mfma_f32_16x16x32_bf16 v[204:207], v[244:247], v[76:79], v[204:207]
s_waitcnt lgkmcnt(8)
ds_read_b64_tr_b16 v[244:245], v253 offset:24576
v_cvt_pk_bf16_f32 v174, v220, v221
v_mfma_f32_16x16x32_bf16 v[196:199], v[224:227], v[80:83], v[196:199]
s_and_b32 s43, s43, 15
ds_read_b64_tr_b16 v[246:247], v253 offset:26624
v_xor_b32 v253, 32, v253
v_mfma_f32_16x16x32_bf16 v[204:207], v[224:227], v[84:87], v[204:207]
s_waitcnt lgkmcnt(8)
ds_read_b64_tr_b16 v[224:225], v253 offset:0
v_cvt_pk_bf16_f32 v175, v222, v223
v_mfma_f32_16x16x32_bf16 v[196:199], v[228:231], v[88:91], v[196:199]
s_lshl_b32 s43, s43, 10
ds_read_b64_tr_b16 v[226:227], v253 offset:2048
buffer_store_dwordx4 v[172:175], v252, s[32:35], s48 offen sc1
v_mfma_f32_16x16x32_bf16 v[204:207], v[228:231], v[92:95], v[204:207]
s_waitcnt lgkmcnt(8)
ds_read_b64_tr_b16 v[228:229], v253 offset:8192
v_mfma_f32_16x16x32_bf16 v[196:199], v[232:235], v[96:99], v[196:199]
s_cselect_b32 s44, s43, 0x7ff00000
ds_read_b64_tr_b16 v[230:231], v253 offset:10240
v_mfma_f32_16x16x32_bf16 v[204:207], v[232:235], v[100:103], v[204:207]
s_waitcnt lgkmcnt(8)
ds_read_b64_tr_b16 v[232:233], v253 offset:16384
v_mfma_f32_16x16x32_bf16 v[196:199], v[236:239], v[104:107], v[196:199]
ds_read_b64_tr_b16 v[234:235], v253 offset:18432
v_mfma_f32_16x16x32_bf16 v[204:207], v[236:239], v[108:111], v[204:207]
s_waitcnt lgkmcnt(8)
ds_read_b64_tr_b16 v[236:237], v253 offset:24576
v_mfma_f32_16x16x32_bf16 v[196:199], v[240:243], v[112:115], v[196:199]
ds_read_b64_tr_b16 v[238:239], v253 offset:26624
v_mfma_f32_16x16x32_bf16 v[204:207], v[240:243], v[116:119], v[204:207]
s_waitcnt lgkmcnt(8)
v_mfma_f32_16x16x32_bf16 v[196:199], v[244:247], v[120:123], v[196:199]
s_add_u32 s47, s42, s44
s_add_u32 s42, s42, 0x4000
v_mfma_f32_16x16x32_bf16 v[204:207], v[244:247], v[124:127], v[204:207]
s_waitcnt lgkmcnt(6)
v_mfma_f32_16x16x32_bf16 v[192:195], v[224:227], v[96:99], v[192:195]
s_sub_u32 s43, s43, 0x400
s_and_b32 s43, s43, 0x3c00
v_mfma_f32_16x16x32_bf16 v[200:203], v[224:227], v[100:103], v[200:203]
s_waitcnt lgkmcnt(4)
v_mfma_f32_16x16x32_bf16 v[192:195], v[228:231], v[104:107], v[192:195]
s_cselect_b32 s44, s43, 0x7ff00000
s_add_u32 s48, s42, s44
v_mfma_f32_16x16x32_bf16 v[200:203], v[228:231], v[108:111], v[200:203]
s_waitcnt lgkmcnt(2)
v_mfma_f32_16x16x32_bf16 v[192:195], v[232:235], v[112:115], v[192:195]
s_add_u32 s46, s46, 2
v_mfma_f32_16x16x32_bf16 v[200:203], v[232:235], v[116:119], v[200:203]
s_waitcnt lgkmcnt(0)
v_mfma_f32_16x16x32_bf16 v[192:195], v[236:239], v[120:123], v[192:195]
s_cmp_ge_u32 s46, 14
s_cselect_b32 s46, 0, s46
v_mfma_f32_16x16x32_bf16 v[200:203], v[236:239], v[124:127], v[200:203]
s_nop 7
v_cvt_pk_bf16_f32 v176, v192, v193
v_cvt_pk_bf16_f32 v177, v194, v195
v_cvt_pk_bf16_f32 v178, v196, v197
v_cvt_pk_bf16_f32 v179, v198, v199
buffer_store_dwordx4 v[176:179], v252, s[32:35], s47 offen sc1
v_cvt_pk_bf16_f32 v180, v200, v201
v_cvt_pk_bf16_f32 v181, v202, v203
v_cvt_pk_bf16_f32 v182, v204, v205
v_cvt_pk_bf16_f32 v183, v206, v207
buffer_store_dwordx4 v[180:183], v252, s[32:35], s48 offen sc1
v_lshrrev_b32 v20, 4, v252
v_and_b32 v21, 15, v20
v_mul_u32_u24 v21, 896, v21
v_lshrrev_b32 v22, 4, v20
v_lshl_add_u32 v21, v22, 3, v21
v_and_b32 v22, 15, v20
v_lshl_add_u32 v22, v22, 2, s69
s_lshl_b32 s57, s23, 2
s_add_u32 s57, s57, s69
v_mov_b32 v23, s57
v_mov_b32 v24, 1
s_lshl_b32 s58, s27, 1
s_sub_u32 s58, s89, s58
s_add_u32 s60, s58, 14
s_cmp_lt_i32 s58, 0
s_cselect_b32 s58, s60, s58
s_lshl_b32 s58, s58, 2
s_set_gpr_idx_on s58, 0x1
s_nop 1
v_mov_b32 v48, v128
v_mov_b32 v49, v129
v_mov_b32 v50, v130
v_mov_b32 v51, v131
s_set_gpr_idx_off
s_nop 1
s_mov_b32 s90, 1
s_lshl_b32 s65, 1, s23
s_cmp_lt_u32 s89, 14
s_cselect_b32 s90, s90, 0
s_cselect_b32 s65, s65, 0
s_mul_i32 s64, s25, 56
s_lshl_b32 s58, s26, 1
s_add_u32 s64, s64, s58
s_lshl_b32 s56, 16, s26
s_mov_b32 s59, 0
s_mov_b32 s67, 0
v_cmp_eq_u32 vcc, v22, v23
s_nop 1
v_cndmask_b32 v29, 0, v24, vcc
s_waitcnt vmcnt(0)
v_mov_b32 v27, v254
v_mov_b32 v26, 0
s_barrier
s_cmp_lg_u32 s26, 0
s_cbranch_scc1 L_fw
s_mov_b64 exec, 1
global_store_dword v23, v24, s[18:19] sc0 sc1
s_mov_b64 exec, -1
v_mov_b32 v28, 0
v_cmp_eq_u32 vcc, 0, v27
s_cmp_eq_u32 s65, 0
s_cbranch_scc1 L_fx
s_cbranch_vccnz L_fx
L_fp:
global_load_dword v25, v22, s[18:19] sc0 sc1
s_add_u32 s59, s59, 1
s_waitcnt vmcnt(0)
v_or_b32 v25, v25, v29
v_cmp_eq_u32 vcc, 0, v25
s_cbranch_vccz L_fs
s_sleep 6
s_cmp_lt_u32 s59, 200
s_cbranch_scc1 L_fp
s_branch L_fx
L_fs:
v_mov_b32 v28, 1
L_fx:
ds_write_b32 v26, v28
s_waitcnt vmcnt(0) lgkmcnt(0)
L_fw:
s_barrier
ds_read_b32 v28, v26
s_mov_b32 s59, 0
s_waitcnt lgkmcnt(0)
v_cmp_ne_u32 vcc, 0, v28
s_cbranch_vccnz L_go
s_cmp_lg_u32 s65, 0
s_cbranch_scc1 L_chk
s_waitcnt vmcnt(0)
global_load_ubyte v27, v250, s[16:17] sc0 sc1
s_waitcnt vmcnt(0)
v_and_b32 v25, s56, v27
v_cmp_ne_u32 vcc, 0, v25
s_cbranch_vccz L_done
L_chk:
v_cmp_eq_u32 vcc, 0, v27
s_cbranch_vccz L_poll
s_sleep 8
global_load_ubyte v27, v250, s[16:17] sc0 sc1
s_add_u32 s59, s59, 1
s_waitcnt vmcnt(0)
s_cmp_lt_u32 s59, 20000
s_cbranch_scc1 L_chk
s_branch L_giveup
L_poll:
global_load_dword v25, v22, s[18:19] sc0 sc1
s_add_u32 s59, s59, 1
s_waitcnt vmcnt(0)
v_or_b32 v25, v25, v29
v_cmp_eq_u32 vcc, 0, v25
s_cbranch_vccz L_go
s_sleep 6
s_cmp_lt_u32 s59, 20000
s_cbranch_scc1 L_poll
L_giveup:
s_cmp_eq_u32 s65, 0
s_cbranch_scc1 L_done
s_lshr_b32 s58, s89, 1
s_lshl_b32 s58, s58, 3
s_and_b32 s60, s89, 1
s_add_u32 s58, s58, s60
s_add_u32 s58, s58, s64
s_lshl_b32 s58, s58, 14
buffer_store_dwordx4 v[48:51], v252, s[32:35], s58 offen sc1
s_waitcnt vmcnt(0)
s_and_b32 s60, s23, 3
s_lshl_b32 s60, s60, 3
s_lshl_b32 s60, s56, s60
v_mov_b32 v24, s60
s_and_b32 s60, s23, 12
s_add_u32 s60, s60, s68
v_mov_b32 v26, s60
s_mov_b64 exec, 1
global_atomic_or v26, v24, s[16:17] sc1
s_mov_b64 exec, -1
s_waitcnt vmcnt(0)
global_load_ubyte v27, v250, s[16:17] sc0 sc1
s_waitcnt vmcnt(0)
global_load_dword v25, v22, s[18:19] sc0 sc1
s_waitcnt vmcnt(0)
v_min_u32 v25, v25, v27
v_cmp_eq_u32 vcc, 0, v25
s_cbranch_vccnz L_done
L_go:
s_cmp_lg_u32 s65, 0
s_cbranch_scc1 L_slices
global_load_ubyte v27, v250, s[16:17] sc0 sc1
s_waitcnt vmcnt(0)
s_branch L_more
L_slices:
s_ff1_i32_b32 s66, s65
s_bitset0_b32 s65, s66
s_bitset1_b32 s67, s66
s_add_u32 s66, s66, s87
s_and_b32 s66, s66, 15
s_lshr_b32 s58, s66, 1
s_lshl_b32 s58, s58, 3
s_and_b32 s66, s66, 1
s_add_u32 s66, s66, s58
s_add_u32 s66, s66, s64
s_lshl_b32 s57, s66, 14
s_cmp_eq_u32 s90, 1
s_mov_b32 s90, 0
s_cbranch_scc1 L_sk0
buffer_load_dwordx4 v[48:51], v252, s[32:35], s57 offen offset:0 sc1
L_sk0:
buffer_load_dwordx4 v[52:55], v252, s[32:35], s57 offen offset:1024 sc1
buffer_load_dwordx4 v[56:59], v252, s[32:35], s57 offen offset:2048 sc1
buffer_load_dwordx4 v[60:63], v252, s[32:35], s57 offen offset:3072 sc1
s_add_u32 s57, s57, 0x1000
buffer_load_dwordx4 v[64:67], v252, s[32:35], s57 offen offset:0 sc1
buffer_load_dwordx4 v[68:71], v252, s[32:35], s57 offen offset:1024 sc1
buffer_load_dwordx4 v[72:75], v252, s[32:35], s57 offen offset:2048 sc1
buffer_load_dwordx4 v[76:79], v252, s[32:35], s57 offen offset:3072 sc1
s_add_u32 s57, s57, 0x1000
buffer_load_dwordx4 v[80:83], v252, s[32:35], s57 offen offset:0 sc1
buffer_load_dwordx4 v[84:87], v252, s[32:35], s57 offen offset:1024 sc1
buffer_load_dwordx4 v[88:91], v252, s[32:35], s57 offen offset:2048 sc1
buffer_load_dwordx4 v[92:95], v252, s[32:35], s57 offen offset:3072 sc1
s_add_u32 s57, s57, 0x1000
buffer_load_dwordx4 v[96:99], v252, s[32:35], s57 offen offset:0 sc1
buffer_load_dwordx4 v[100:103], v252, s[32:35], s57 offen offset:1024 sc1
buffer_load_dwordx4 v[104:107], v252, s[32:35], s57 offen offset:2048 sc1
buffer_load_dwordx4 v[108:111], v252, s[32:35], s57 offen offset:3072 sc1
global_load_ubyte v27, v250, s[16:17] sc0 sc1
s_mov_b32 s58, 76695845
s_mul_hi_u32 s59, s66, s58
s_mul_i32 s60, s59, 56
s_sub_u32 s60, s66, s60
s_lshl_b32 s61, s59, 6
s_bfe_u32 s62, s60, 0x10001
s_lshl_b32 s62, s62, 5
s_add_u32 s61, s61, s62
s_mul_i32 s61, s61, 896
s_lshr_b32 s62, s60, 3
s_lshl_b32 s62, s62, 7
s_add_u32 s61, s61, s62
s_bfe_u32 s62, s60, 0x10002
s_lshl_b32 s62, s62, 6
s_add_u32 s61, s61, s62
s_and_b32 s62, s60, 1
s_mul_i32 s62, s62, 14336
s_add_u32 s61, s61, s62
s_mov_b32 s63, 0xffff0000
s_waitcnt vmcnt(16)
v_lshlrev_b32 v40, 16, v48
v_and_b32 v41, s63, v48
v_lshlrev_b32 v42, 16, v49
v_and_b32 v43, s63, v49
v_lshlrev_b32 v44, 16, v50
v_and_b32 v45, s63, v50
v_lshlrev_b32 v46, 16, v51
v_and_b32 v47, s63, v51
s_waitcnt vmcnt(15)
v_lshlrev_b32 v37, 16, v52
v_and_b32 v38, s63, v52
v_add_f32 v40, v40, v37
v_add_f32 v41, v41, v38
v_lshlrev_b32 v37, 16, v53
v_and_b32 v38, s63, v53
v_add_f32 v42, v42, v37
v_add_f32 v43, v43, v38
v_lshlrev_b32 v37, 16, v54
v_and_b32 v38, s63, v54
v_add_f32 v44, v44, v37
v_add_f32 v45, v45, v38
v_lshlrev_b32 v37, 16, v55
v_and_b32 v38, s63, v55
v_add_f32 v46, v46, v37
v_add_f32 v47, v47, v38
s_waitcnt vmcnt(14)
v_lshlrev_b32 v37, 16, v56
v_and_b32 v38, s63, v56
v_add_f32 v40, v40, v37
v_add_f32 v41, v41, v38
v_lshlrev_b32 v37, 16, v57
v_and_b32 v38, s63, v57
v_add_f32 v42, v42, v37
v_add_f32 v43, v43, v38
v_lshlrev_b32 v37, 16, v58
v_and_b32 v38, s63, v58
v_add_f32 v44, v44, v37
v_add_f32 v45, v45, v38
v_lshlrev_b32 v37, 16, v59
v_and_b32 v38, s63, v59
v_add_f32 v46, v46, v37
v_add_f32 v47, v47, v38
s_waitcnt vmcnt(13)
v_lshlrev_b32 v37, 16, v60
v_and_b32 v38, s63, v60
v_add_f32 v40, v40, v37
v_add_f32 v41, v41, v38
v_lshlrev_b32 v37, 16, v61
v_and_b32 v38, s63, v61
v_add_f32 v42, v42, v37
v_add_f32 v43, v43, v38
v_lshlrev_b32 v37, 16, v62
v_and_b32 v38, s63, v62
v_add_f32 v44, v44, v37
v_add_f32 v45, v45, v38
v_lshlrev_b32 v37, 16, v63
v_and_b32 v38, s63, v63
v_add_f32 v46, v46, v37
v_add_f32 v47, v47, v38
s_waitcnt vmcnt(12)
v_lshlrev_b32 v37, 16, v64
v_and_b32 v38, s63, v64
v_add_f32 v40, v40, v37
v_add_f32 v41, v41, v38
v_lshlrev_b32 v37, 16, v65
v_and_b32 v38, s63, v65
v_add_f32 v42, v42, v37
v_add_f32 v43, v43, v38
v_lshlrev_b32 v37, 16, v66
v_and_b32 v38, s63, v66
v_add_f32 v44, v44, v37
v_add_f32 v45, v45, v38
v_lshlrev_b32 v37, 16, v67
v_and_b32 v38, s63, v67
v_add_f32 v46, v46, v37
v_add_f32 v47, v47, v38
s_waitcnt vmcnt(11)
v_lshlrev_b32 v37, 16, v68
v_and_b32 v38, s63, v68
v_add_f32 v40, v40, v37
v_add_f32 v41, v41, v38
v_lshlrev_b32 v37, 16, v69
v_and_b32 v38, s63, v69
v_add_f32 v42, v42, v37
v_add_f32 v43, v43, v38
v_lshlrev_b32 v37, 16, v70
v_and_b32 v38, s63, v70
v_add_f32 v44, v44, v37
v_add_f32 v45, v45, v38
v_lshlrev_b32 v37, 16, v71
v_and_b32 v38, s63, v71
v_add_f32 v46, v46, v37
v_add_f32 v47, v47, v38
s_waitcnt vmcnt(10)
v_lshlrev_b32 v37, 16, v72
v_and_b32 v38, s63, v72
v_add_f32 v40, v40, v37
v_add_f32 v41, v41, v38
v_lshlrev_b32 v37, 16, v73
v_and_b32 v38, s63, v73
v_add_f32 v42, v42, v37
v_add_f32 v43, v43, v38
v_lshlrev_b32 v37, 16, v74
v_and_b32 v38, s63, v74
v_add_f32 v44, v44, v37
v_add_f32 v45, v45, v38
v_lshlrev_b32 v37, 16, v75
v_and_b32 v38, s63, v75
v_add_f32 v46, v46, v37
v_add_f32 v47, v47, v38
s_waitcnt vmcnt(9)
v_lshlrev_b32 v37, 16, v76
v_and_b32 v38, s63, v76
v_add_f32 v40, v40, v37
v_add_f32 v41, v41, v38
v_lshlrev_b32 v37, 16, v77
v_and_b32 v38, s63, v77
v_add_f32 v42, v42, v37
v_add_f32 v43, v43, v38
v_lshlrev_b32 v37, 16, v78
v_and_b32 v38, s63, v78
v_add_f32 v44, v44, v37
v_add_f32 v45, v45, v38
v_lshlrev_b32 v37, 16, v79
v_and_b32 v38, s63, v79
v_add_f32 v46, v46, v37
v_add_f32 v47, v47, v38
s_waitcnt vmcnt(8)
v_lshlrev_b32 v37, 16, v80
v_and_b32 v38, s63, v80
v_add_f32 v40, v40, v37
v_add_f32 v41, v41, v38
v_lshlrev_b32 v37, 16, v81
v_and_b32 v38, s63, v81
v_add_f32 v42, v42, v37
v_add_f32 v43, v43, v38
v_lshlrev_b32 v37, 16, v82
v_and_b32 v38, s63, v82
v_add_f32 v44, v44, v37
v_add_f32 v45, v45, v38
v_lshlrev_b32 v37, 16, v83
v_and_b32 v38, s63, v83
v_add_f32 v46, v46, v37
v_add_f32 v47, v47, v38
s_waitcnt vmcnt(7)
v_lshlrev_b32 v37, 16, v84
v_and_b32 v38, s63, v84
v_add_f32 v40, v40, v37
v_add_f32 v41, v41, v38
v_lshlrev_b32 v37, 16, v85
v_and_b32 v38, s63, v85
v_add_f32 v42, v42, v37
v_add_f32 v43, v43, v38
v_lshlrev_b32 v37, 16, v86
v_and_b32 v38, s63, v86
v_add_f32 v44, v44, v37
v_add_f32 v45, v45, v38
v_lshlrev_b32 v37, 16, v87
v_and_b32 v38, s63, v87
v_add_f32 v46, v46, v37
v_add_f32 v47, v47, v38
s_waitcnt vmcnt(6)
v_lshlrev_b32 v37, 16, v88
v_and_b32 v38, s63, v88
v_add_f32 v40, v40, v37
v_add_f32 v41, v41, v38
v_lshlrev_b32 v37, 16, v89
v_and_b32 v38, s63, v89
v_add_f32 v42, v42, v37
v_add_f32 v43, v43, v38
v_lshlrev_b32 v37, 16, v90
v_and_b32 v38, s63, v90
v_add_f32 v44, v44, v37
v_add_f32 v45, v45, v38
v_lshlrev_b32 v37, 16, v91
v_and_b32 v38, s63, v91
v_add_f32 v46, v46, v37
v_add_f32 v47, v47, v38
s_waitcnt vmcnt(5)
v_lshlrev_b32 v37, 16, v92
v_and_b32 v38, s63, v92
v_add_f32 v40, v40, v37
v_add_f32 v41, v41, v38
v_lshlrev_b32 v37, 16, v93
v_and_b32 v38, s63, v93
v_add_f32 v42, v42, v37
v_add_f32 v43, v43, v38
v_lshlrev_b32 v37, 16, v94
v_and_b32 v38, s63, v94
v_add_f32 v44, v44, v37
v_add_f32 v45, v45, v38
v_lshlrev_b32 v37, 16, v95
v_and_b32 v38, s63, v95
v_add_f32 v46, v46, v37
v_add_f32 v47, v47, v38
s_waitcnt vmcnt(4)
v_lshlrev_b32 v37, 16, v96
v_and_b32 v38, s63, v96
v_add_f32 v40, v40, v37
v_add_f32 v41, v41, v38
v_lshlrev_b32 v37, 16, v97
v_and_b32 v38, s63, v97
v_add_f32 v42, v42, v37
v_add_f32 v43, v43, v38
v_lshlrev_b32 v37, 16, v98
v_and_b32 v38, s63, v98
v_add_f32 v44, v44, v37
v_add_f32 v45, v45, v38
v_lshlrev_b32 v37, 16, v99
v_and_b32 v38, s63, v99
v_add_f32 v46, v46, v37
v_add_f32 v47, v47, v38
s_waitcnt vmcnt(3)
v_lshlrev_b32 v37, 16, v100
v_and_b32 v38, s63, v100
v_add_f32 v40, v40, v37
v_add_f32 v41, v41, v38
v_lshlrev_b32 v37, 16, v101
v_and_b32 v38, s63, v101
v_add_f32 v42, v42, v37
v_add_f32 v43, v43, v38
v_lshlrev_b32 v37, 16, v102
v_and_b32 v38, s63, v102
v_add_f32 v44, v44, v37
v_add_f32 v45, v45, v38
v_lshlrev_b32 v37, 16, v103
v_and_b32 v38, s63, v103
v_add_f32 v46, v46, v37
v_add_f32 v47, v47, v38
s_waitcnt vmcnt(2)
v_lshlrev_b32 v37, 16, v104
v_and_b32 v38, s63, v104
v_add_f32 v40, v40, v37
v_add_f32 v41, v41, v38
v_lshlrev_b32 v37, 16, v105
v_and_b32 v38, s63, v105
v_add_f32 v42, v42, v37
v_add_f32 v43, v43, v38
v_lshlrev_b32 v37, 16, v106
v_and_b32 v38, s63, v106
v_add_f32 v44, v44, v37
v_add_f32 v45, v45, v38
v_lshlrev_b32 v37, 16, v107
v_and_b32 v38, s63, v107
v_add_f32 v46, v46, v37
v_add_f32 v47, v47, v38
s_waitcnt vmcnt(1)
v_lshlrev_b32 v37, 16, v108
v_and_b32 v38, s63, v108
v_add_f32 v40, v40, v37
v_add_f32 v41, v41, v38
v_lshlrev_b32 v37, 16, v109
v_and_b32 v38, s63, v109
v_add_f32 v42, v42, v37
v_add_f32 v43, v43, v38
v_lshlrev_b32 v37, 16, v110
v_and_b32 v38, s63, v110
v_add_f32 v44, v44, v37
v_add_f32 v45, v45, v38
v_lshlrev_b32 v37, 16, v111
v_and_b32 v38, s63, v111
v_add_f32 v46, v46, v37
v_add_f32 v47, v47, v38
v_cvt_pk_bf16_f32 v48, v40, v41
v_cvt_pk_bf16_f32 v49, v42, v43
v_cvt_pk_bf16_f32 v50, v44, v45
v_cvt_pk_bf16_f32 v51, v46, v47
buffer_store_dwordx2 v[48:49], v21, s[52:55], s61 offen
buffer_store_dwordx2 v[50:51], v21, s[52:55], s61 offen offset:32
s_waitcnt vmcnt(2)
L_more:
v_and_b32 v25, s56, v27
v_cmp_ne_u32 vcc, 0, v25
s_nop 1
s_and_b32 s58, vcc_lo, 0xffff
s_andn2_b32 s58, s58, s67
s_or_b32 s65, s65, s58
s_cbranch_scc1 L_slices
L_done:
s_endpgm
L_code_end:
L_stub1:
s_call_b64 s[92:93], L_rare1
s_branch L_back1
L_stub2:
s_call_b64 s[92:93], L_rare0
s_branch L_back2
L_stub3:
s_call_b64 s[92:93], L_rare1
s_branch L_back3
L_stub4:
s_call_b64 s[92:93], L_rare0
s_branch L_back4
L_stub15:
s_call_b64 s[92:93], L_rare1
s_branch L_back15
L_rare0:
v_max3_f32 v216, v192, v193, v194
v_max3_f32 v216, v216, v195, v196
v_max3_f32 v216, v216, v197, v198
v_max3_f32 v216, v216, v199, 0
v_mov_b32 v217, v216
s_nop 1
v_permlane32_swap_b32 v216, v217
s_nop 0
v_max_f32 v216, v216, v217
v_mov_b32 v217, v216
s_nop 1
v_permlane16_swap_b32 v216, v217
s_nop 0
v_max_f32 v216, v216, v217
v_ceil_f32 v216, v216
v_sub_f32 v244, v244, v216
v_sub_f32 v245, v245, v216
v_sub_f32 v246, v246, v216
v_sub_f32 v247, v247, v216
v_exp_f32 v217, -v216
v_sub_f32 v192, v192, v216
v_sub_f32 v193, v193, v216
v_sub_f32 v194, v194, v216
v_sub_f32 v195, v195, v216
v_sub_f32 v196, v196, v216
v_sub_f32 v197, v197, v216
v_sub_f32 v198, v198, v216
v_sub_f32 v199, v199, v216
v_mul_f32 v254, v254, v217
v_lshlrev_b32 v218, 16, v208
v_and_b32 v219, s63, v208
v_mul_f32 v218, v218, v217
v_mul_f32 v219, v219, v217
v_cvt_pk_bf16_f32 v208, v218, v219
v_lshlrev_b32 v218, 16, v209
v_and_b32 v219, s63, v209
v_mul_f32 v218, v218, v217
v_mul_f32 v219, v219, v217
v_cvt_pk_bf16_f32 v209, v218, v219
v_lshlrev_b32 v218, 16, v210
v_and_b32 v219, s63, v210
v_mul_f32 v218, v218, v217
v_mul_f32 v219, v219, v217
v_cvt_pk_bf16_f32 v210, v218, v219
v_lshlrev_b32 v218, 16, v211
v_and_b32 v219, s63, v211
v_mul_f32 v218, v218, v217
v_mul_f32 v219, v219, v217
v_cvt_pk_bf16_f32 v211, v218, v219
v_mul_f32 v0, v0, v217
v_mul_f32 v1, v1, v217
v_mul_f32 v2, v2, v217
v_mul_f32 v3, v3, v217
v_mul_f32 v4, v4, v217
v_mul_f32 v5, v5, v217
v_mul_f32 v6, v6, v217
v_mul_f32 v7, v7, v217
v_mul_f32 v16, v16, v217
v_mul_f32 v17, v17, v217
v_mul_f32 v18, v18, v217
v_mul_f32 v19, v19, v217
v_mul_f32 v20, v20, v217
v_mul_f32 v21, v21, v217
v_mul_f32 v22, v22, v217
v_mul_f32 v23, v23, v217
v_mul_f32 v32, v32, v217
v_mul_f32 v33, v33, v217
v_mul_f32 v34, v34, v217
v_mul_f32 v35, v35, v217
v_mul_f32 v36, v36, v217
v_mul_f32 v37, v37, v217
v_mul_f32 v38, v38, v217
v_mul_f32 v39, v39, v217
v_mul_f32 v48, v48, v217
v_mul_f32 v49, v49, v217
v_mul_f32 v50, v50, v217
v_mul_f32 v51, v51, v217
v_mul_f32 v52, v52, v217
v_mul_f32 v53, v53, v217
v_mul_f32 v54, v54, v217
v_mul_f32 v55, v55, v217
v_mul_f32 v64, v64, v217
v_mul_f32 v65, v65, v217
v_mul_f32 v66, v66, v217
v_mul_f32 v67, v67, v217
v_mul_f32 v68, v68, v217
v_mul_f32 v69, v69, v217
v_mul_f32 v70, v70, v217
v_mul_f32 v71, v71, v217
v_mul_f32 v80, v80, v217
v_mul_f32 v81, v81, v217
v_mul_f32 v82, v82, v217
v_mul_f32 v83, v83, v217
v_mul_f32 v84, v84, v217
v_mul_f32 v85, v85, v217
v_mul_f32 v86, v86, v217
v_mul_f32 v87, v87, v217
v_mul_f32 v96, v96, v217
v_mul_f32 v97, v97, v217
v_mul_f32 v98, v98, v217
v_mul_f32 v99, v99, v217
v_mul_f32 v100, v100, v217
v_mul_f32 v101, v101, v217
v_mul_f32 v102, v102, v217
v_mul_f32 v103, v103, v217
v_mul_f32 v112, v112, v217
v_mul_f32 v113, v113, v217
v_mul_f32 v114, v114, v217
v_mul_f32 v115, v115, v217
v_mul_f32 v116, v116, v217
v_mul_f32 v117, v117, v217
v_mul_f32 v118, v118, v217
v_mul_f32 v119, v119, v217
v_max3_f32 v216, v200, v201, v202
v_max3_f32 v216, v216, v203, v204
v_max3_f32 v216, v216, v205, v206
v_max3_f32 v216, v216, v207, 0
v_mov_b32 v217, v216
s_nop 1
v_permlane32_swap_b32 v216, v217
s_nop 0
v_max_f32 v216, v216, v217
v_mov_b32 v217, v216
s_nop 1
v_permlane16_swap_b32 v216, v217
s_nop 0
v_max_f32 v216, v216, v217
v_ceil_f32 v216, v216
v_sub_f32 v248, v248, v216
v_sub_f32 v249, v249, v216
v_sub_f32 v250, v250, v216
v_sub_f32 v251, v251, v216
v_exp_f32 v217, -v216
v_sub_f32 v200, v200, v216
v_sub_f32 v201, v201, v216
v_sub_f32 v202, v202, v216
v_sub_f32 v203, v203, v216
v_sub_f32 v204, v204, v216
v_sub_f32 v205, v205, v216
v_sub_f32 v206, v206, v216
v_sub_f32 v207, v207, v216
v_mul_f32 v255, v255, v217
v_lshlrev_b32 v218, 16, v212
v_and_b32 v219, s63, v212
v_mul_f32 v218, v218, v217
v_mul_f32 v219, v219, v217
v_cvt_pk_bf16_f32 v212, v218, v219
v_lshlrev_b32 v218, 16, v213
v_and_b32 v219, s63, v213
v_mul_f32 v218, v218, v217
v_mul_f32 v219, v219, v217
v_cvt_pk_bf16_f32 v213, v218, v219
v_lshlrev_b32 v218, 16, v214
v_and_b32 v219, s63, v214
v_mul_f32 v218, v218, v217
v_mul_f32 v219, v219, v217
v_cvt_pk_bf16_f32 v214, v218, v219
v_lshlrev_b32 v218, 16, v215
v_and_b32 v219, s63, v215
v_mul_f32 v218, v218, v217
v_mul_f32 v219, v219, v217
v_cvt_pk_bf16_f32 v215, v218, v219
v_mul_f32 v8, v8, v217
v_mul_f32 v9, v9, v217
v_mul_f32 v10, v10, v217
v_mul_f32 v11, v11, v217
v_mul_f32 v12, v12, v217
v_mul_f32 v13, v13, v217
v_mul_f32 v14, v14, v217
v_mul_f32 v15, v15, v217
v_mul_f32 v24, v24, v217
v_mul_f32 v25, v25, v217
v_mul_f32 v26, v26, v217
v_mul_f32 v27, v27, v217
v_mul_f32 v28, v28, v217
v_mul_f32 v29, v29, v217
v_mul_f32 v30, v30, v217
v_mul_f32 v31, v31, v217
v_mul_f32 v40, v40, v217
v_mul_f32 v41, v41, v217
v_mul_f32 v42, v42, v217
v_mul_f32 v43, v43, v217
v_mul_f32 v44, v44, v217
v_mul_f32 v45, v45, v217
v_mul_f32 v46, v46, v217
v_mul_f32 v47, v47, v217
v_mul_f32 v56, v56, v217
v_mul_f32 v57, v57, v217
v_mul_f32 v58, v58, v217
v_mul_f32 v59, v59, v217
v_mul_f32 v60, v60, v217
v_mul_f32 v61, v61, v217
v_mul_f32 v62, v62, v217
v_mul_f32 v63, v63, v217
v_mul_f32 v72, v72, v217
v_mul_f32 v73, v73, v217
v_mul_f32 v74, v74, v217
v_mul_f32 v75, v75, v217
v_mul_f32 v76, v76, v217
v_mul_f32 v77, v77, v217
v_mul_f32 v78, v78, v217
v_mul_f32 v79, v79, v217
v_mul_f32 v88, v88, v217
v_mul_f32 v89, v89, v217
v_mul_f32 v90, v90, v217
v_mul_f32 v91, v91, v217
v_mul_f32 v92, v92, v217
v_mul_f32 v93, v93, v217
v_mul_f32 v94, v94, v217
v_mul_f32 v95, v95, v217
v_mul_f32 v104, v104, v217
v_mul_f32 v105, v105, v217
v_mul_f32 v106, v106, v217
v_mul_f32 v107, v107, v217
v_mul_f32 v108, v108, v217
v_mul_f32 v109, v109, v217
v_mul_f32 v110, v110, v217
v_mul_f32 v111, v111, v217
v_mul_f32 v120, v120, v217
v_mul_f32 v121, v121, v217
v_mul_f32 v122, v122, v217
v_mul_f32 v123, v123, v217
v_mul_f32 v124, v124, v217
v_mul_f32 v125, v125, v217
v_mul_f32 v126, v126, v217
v_mul_f32 v127, v127, v217
s_nop 1
s_setpc_b64 s[92:93]
L_rare1:
v_max3_f32 v200, v208, v209, v210
v_max3_f32 v200, v200, v211, v212
v_max3_f32 v200, v200, v213, v214
v_max3_f32 v200, v200, v215, 0
v_mov_b32 v201, v200
s_nop 1
v_permlane32_swap_b32 v200, v201
s_nop 0
v_max_f32 v200, v200, v201
v_mov_b32 v201, v200
s_nop 1
v_permlane16_swap_b32 v200, v201
s_nop 0
v_max_f32 v200, v200, v201
v_ceil_f32 v200, v200
v_sub_f32 v244, v244, v200
v_sub_f32 v245, v245, v200
v_sub_f32 v246, v246, v200
v_sub_f32 v247, v247, v200
v_exp_f32 v201, -v200
v_sub_f32 v208, v208, v200
v_sub_f32 v209, v209, v200
v_sub_f32 v210, v210, v200
v_sub_f32 v211, v211, v200
v_sub_f32 v212, v212, v200
v_sub_f32 v213, v213, v200
v_sub_f32 v214, v214, v200
v_sub_f32 v215, v215, v200
v_mul_f32 v254, v254, v201
v_lshlrev_b32 v202, 16, v192
v_and_b32 v203, s63, v192
v_mul_f32 v202, v202, v201
v_mul_f32 v203, v203, v201
v_cvt_pk_bf16_f32 v192, v202, v203
v_lshlrev_b32 v202, 16, v193
v_and_b32 v203, s63, v193
v_mul_f32 v202, v202, v201
v_mul_f32 v203, v203, v201
v_cvt_pk_bf16_f32 v193, v202, v203
v_lshlrev_b32 v202, 16, v194
v_and_b32 v203, s63, v194
v_mul_f32 v202, v202, v201
v_mul_f32 v203, v203, v201
v_cvt_pk_bf16_f32 v194, v202, v203
v_lshlrev_b32 v202, 16, v195
v_and_b32 v203, s63, v195
v_mul_f32 v202, v202, v201
v_mul_f32 v203, v203, v201
v_cvt_pk_bf16_f32 v195, v202, v203
v_mul_f32 v0, v0, v201
v_mul_f32 v1, v1, v201
v_mul_f32 v2, v2, v201
v_mul_f32 v3, v3, v201
v_mul_f32 v4, v4, v201
v_mul_f32 v5, v5, v201
v_mul_f32 v6, v6, v201
v_mul_f32 v7, v7, v201
v_mul_f32 v16, v16, v201
v_mul_f32 v17, v17, v201
v_mul_f32 v18, v18, v201
v_mul_f32 v19, v19, v201
v_mul_f32 v20, v20, v201
v_mul_f32 v21, v21, v201
v_mul_f32 v22, v22, v201
v_mul_f32 v23, v23, v201
v_mul_f32 v32, v32, v201
v_mul_f32 v33, v33, v201
v_mul_f32 v34, v34, v201
v_mul_f32 v35, v35, v201
v_mul_f32 v36, v36, v201
v_mul_f32 v37, v37, v201
v_mul_f32 v38, v38, v201
v_mul_f32 v39, v39, v201
v_mul_f32 v48, v48, v201
v_mul_f32 v49, v49, v201
v_mul_f32 v50, v50, v201
v_mul_f32 v51, v51, v201
v_mul_f32 v52, v52, v201
v_mul_f32 v53, v53, v201
v_mul_f32 v54, v54, v201
v_mul_f32 v55, v55, v201
v_mul_f32 v64, v64, v201
v_mul_f32 v65, v65, v201
v_mul_f32 v66, v66, v201
v_mul_f32 v67, v67, v201
v_mul_f32 v68, v68, v201
v_mul_f32 v69, v69, v201
v_mul_f32 v70, v70, v201
v_mul_f32 v71, v71, v201
v_mul_f32 v80, v80, v201
v_mul_f32 v81, v81, v201
v_mul_f32 v82, v82, v201
v_mul_f32 v83, v83, v201
v_mul_f32 v84, v84, v201
v_mul_f32 v85, v85, v201
v_mul_f32 v86, v86, v201
v_mul_f32 v87, v87, v201
v_mul_f32 v96, v96, v201
v_mul_f32 v97, v97, v201
v_mul_f32 v98, v98, v201
v_mul_f32 v99, v99, v201
v_mul_f32 v100, v100, v201
v_mul_f32 v101, v101, v201
v_mul_f32 v102, v102, v201
v_mul_f32 v103, v103, v201
v_mul_f32 v112, v112, v201
v_mul_f32 v113, v113, v201
v_mul_f32 v114, v114, v201
v_mul_f32 v115, v115, v201
v_mul_f32 v116, v116, v201
v_mul_f32 v117, v117, v201
v_mul_f32 v118, v118, v201
v_mul_f32 v119, v119, v201
v_max3_f32 v200, v216, v217, v218
v_max3_f32 v200, v200, v219, v220
v_max3_f32 v200, v200, v221, v222
v_max3_f32 v200, v200, v223, 0
v_mov_b32 v201, v200
s_nop 1
v_permlane32_swap_b32 v200, v201
s_nop 0
v_max_f32 v200, v200, v201
v_mov_b32 v201, v200
s_nop 1
v_permlane16_swap_b32 v200, v201
s_nop 0
v_max_f32 v200, v200, v201
v_ceil_f32 v200, v200
v_sub_f32 v248, v248, v200
v_sub_f32 v249, v249, v200
v_sub_f32 v250, v250, v200
v_sub_f32 v251, v251, v200
v_exp_f32 v201, -v200
v_sub_f32 v216, v216, v200
v_sub_f32 v217, v217, v200
v_sub_f32 v218, v218, v200
v_sub_f32 v219, v219, v200
v_sub_f32 v220, v220, v200
v_sub_f32 v221, v221, v200
v_sub_f32 v222, v222, v200
v_sub_f32 v223, v223, v200
v_mul_f32 v255, v255, v201
v_lshlrev_b32 v202, 16, v196
v_and_b32 v203, s63, v196
v_mul_f32 v202, v202, v201
v_mul_f32 v203, v203, v201
v_cvt_pk_bf16_f32 v196, v202, v203
v_lshlrev_b32 v202, 16, v197
v_and_b32 v203, s63, v197
v_mul_f32 v202, v202, v201
v_mul_f32 v203, v203, v201
v_cvt_pk_bf16_f32 v197, v202, v203
v_lshlrev_b32 v202, 16, v198
v_and_b32 v203, s63, v198
v_mul_f32 v202, v202, v201
v_mul_f32 v203, v203, v201
v_cvt_pk_bf16_f32 v198, v202, v203
v_lshlrev_b32 v202, 16, v199
v_and_b32 v203, s63, v199
v_mul_f32 v202, v202, v201
v_mul_f32 v203, v203, v201
v_cvt_pk_bf16_f32 v199, v202, v203
v_mul_f32 v8, v8, v201
v_mul_f32 v9, v9, v201
v_mul_f32 v10, v10, v201
v_mul_f32 v11, v11, v201
v_mul_f32 v12, v12, v201
v_mul_f32 v13, v13, v201
v_mul_f32 v14, v14, v201
v_mul_f32 v15, v15, v201
v_mul_f32 v24, v24, v201
v_mul_f32 v25, v25, v201
v_mul_f32 v26, v26, v201
v_mul_f32 v27, v27, v201
v_mul_f32 v28, v28, v201
v_mul_f32 v29, v29, v201
v_mul_f32 v30, v30, v201
v_mul_f32 v31, v31, v201
v_mul_f32 v40, v40, v201
v_mul_f32 v41, v41, v201
v_mul_f32 v42, v42, v201
v_mul_f32 v43, v43, v201
v_mul_f32 v44, v44, v201
v_mul_f32 v45, v45, v201
v_mul_f32 v46, v46, v201
v_mul_f32 v47, v47, v201
v_mul_f32 v56, v56, v201
v_mul_f32 v57, v57, v201
v_mul_f32 v58, v58, v201
v_mul_f32 v59, v59, v201
v_mul_f32 v60, v60, v201
v_mul_f32 v61, v61, v201
v_mul_f32 v62, v62, v201
v_mul_f32 v63, v63, v201
v_mul_f32 v72, v72, v201
v_mul_f32 v73, v73, v201
v_mul_f32 v74, v74, v201
v_mul_f32 v75, v75, v201
v_mul_f32 v76, v76, v201
v_mul_f32 v77, v77, v201
v_mul_f32 v78, v78, v201
v_mul_f32 v79, v79, v201
v_mul_f32 v88, v88, v201
v_mul_f32 v89, v89, v201
v_mul_f32 v90, v90, v201
v_mul_f32 v91, v91, v201
v_mul_f32 v92, v92, v201
v_mul_f32 v93, v93, v201
v_mul_f32 v94, v94, v201
v_mul_f32 v95, v95, v201
v_mul_f32 v104, v104, v201
v_mul_f32 v105, v105, v201
v_mul_f32 v106, v106, v201
v_mul_f32 v107, v107, v201
v_mul_f32 v108, v108, v201
v_mul_f32 v109, v109, v201
v_mul_f32 v110, v110, v201
v_mul_f32 v111, v111, v201
v_mul_f32 v120, v120, v201
v_mul_f32 v121, v121, v201
v_mul_f32 v122, v122, v201
v_mul_f32 v123, v123, v201
v_mul_f32 v124, v124, v201
v_mul_f32 v125, v125, v201
v_mul_f32 v126, v126, v201
v_mul_f32 v127, v127, v201
s_nop 1
s_setpc_b64 s[92:93]
L_mk0:
s_call_b64 s[92:93], L_mark0
s_branch L_mkb0
L_mk1:
s_call_b64 s[92:93], L_mark1
s_branch L_mkb1
L_mk2:
s_call_b64 s[92:93], L_mark0
s_branch L_mkb2
L_mk3:
s_call_b64 s[92:93], L_mark1
s_branch L_mkb3
L_mk14:
s_call_b64 s[92:93], L_mark0
s_branch L_mkb14
L_mark0:
v_mov_b32 v204, s88
v_mov_b32 v205, 1
s_waitcnt vmcnt(0)
s_mov_b64 exec, 1
global_store_byte v204, v205, s[16:17] sc0 sc1
s_mov_b64 exec, -1
s_setpc_b64 s[92:93]
L_mark1:
v_mov_b32 v220, s88
v_mov_b32 v221, 1
s_waitcnt vmcnt(0)
s_mov_b64 exec, 1
global_store_byte v220, v221, s[16:17] sc0 sc1
s_mov_b64 exec, -1
s_setpc_b64 s[92:93]
L_end:
s_endpgm
.section .rodata,"a"
.p2align 6
.amdhsa_kernel standalone__gqa_block_cached__near_ridge_kernel
  .amdhsa_next_free_vgpr 256
  .amdhsa_next_free_sgpr 100
  .amdhsa_accum_offset 256
  .amdhsa_group_segment_fixed_size 0
  .amdhsa_kernarg_size 64
  .amdhsa_user_sgpr_count 2
  .amdhsa_user_sgpr_kernarg_segment_ptr 1
  .amdhsa_system_sgpr_workgroup_id_x 1
  .amdhsa_float_denorm_mode_32 3
.end_amdhsa_kernel
```
